```python
import torch

def _softmax(x, axis=-1):
    return torch.softmax(x, dim=axis)
def _gelu(x):
    return torch.nn.functional.gelu(x, approximate="tanh")
def _silu(x):
    return torch.nn.functional.silu(x)
def _sigmoid(x):
    return torch.sigmoid(x)
def _layernorm(x, axis=-1, eps=1e-5):
    m = x.mean(dim=axis, keepdim=True)
    v = x.var(dim=axis, keepdim=True, unbiased=False)
    return (x - m) / torch.sqrt(v + eps)
def _scatter_add(tgt, idx, src, axis=0):
    return tgt.clone().index_add_(axis, idx, src)
def _segment_sum(src, seg, n):
    out = torch.zeros((n,) + src.shape[1:], dtype=src.dtype)
    return out.index_add_(0, seg, src)
def _pad(x, pw):
    flat = tuple(v for pair in reversed(pw) for v in pair)
    return torch.nn.functional.pad(x, flat)

kernel_name = 'interleave_layers__grouped_kv_mqa__mixer_token_mlp__prompt'

def setup_inputs():

    _w = (lambda a: (lambda t: t.to(torch.bfloat16) if t.is_floating_point() else t)(torch.as_tensor(a)))
    def _A_setup():
        B, S, D, H = 1, 2048, 640, 32
        Dh = D // H
        return {
            "x": _w((lambda *s: torch.randn(*s, dtype=torch.bfloat16) * 0.05)(B, S, D)),
            "wq": _w((lambda *s: torch.randn(*s, dtype=torch.bfloat16) * 0.05)(D, H * Dh)),
            "wk": _w((lambda *s: torch.randn(*s, dtype=torch.bfloat16) * 0.05)(D, Dh)),
            "wv": _w((lambda *s: torch.randn(*s, dtype=torch.bfloat16) * 0.05)(D, Dh)),
            "wo": _w((lambda *s: torch.randn(*s, dtype=torch.bfloat16) * 0.05)(H * Dh, D)),
        }
    _A_in = _A_setup()

    def _B_setup():
        B, S, D, F = 1, 2048, 640, 1728
        return {
            "x": _w((lambda *s: torch.randn(*s, dtype=torch.bfloat16) * 0.05)(B, S, D)),
            "w1": _w((lambda *s: torch.randn(*s, dtype=torch.bfloat16) * 0.4)(S, F) * (S ** -0.5)),
            "b1": _w((lambda *s: torch.randn(*s, dtype=torch.bfloat16) * 0.4)(F) * 0.02),
            "w2": _w((lambda *s: torch.randn(*s, dtype=torch.bfloat16) * 0.4)(F, S) * (F ** -0.5)),
            "b2": _w((lambda *s: torch.randn(*s, dtype=torch.bfloat16) * 0.4)(S) * 0.02),
        }
    _B_in = _B_setup()

    return {
        "A_x": _A_in["x"],
        "A_wq": _A_in["wq"],
        "A_wk": _A_in["wk"],
        "A_wv": _A_in["wv"],
        "A_wo": _A_in["wo"],
        "B_x": _B_in["x"],
        "B_w1": _B_in["w1"],
        "B_b1": _B_in["b1"],
        "B_w2": _B_in["w2"],
        "B_b2": _B_in["b2"],
    }

def reference(A_x, A_wq, A_wk, A_wv, A_wo, B_x, B_w1, B_b1, B_w2, B_b2):
    def _A_ref(x, wq, wk, wv, wo):
        B, S, D = x.shape
        H = 32
        Dh = D // H
        q = (lambda x, *d: x.permute(*d))((x @ wq).reshape(B, S, H, Dh), 0, 2, 1, 3)
        k = x @ wk
        v = x @ wv
        scores = torch.einsum("bhqd,bkd->bhqk", q, k) * (Dh ** -0.5)
        p = _softmax(scores, axis=-1)
        o = torch.einsum("bhqk,bkd->bhqd", p, v)
        return (lambda x, *d: x.permute(*d))(o, 0, 2, 1, 3).reshape(B, S, H * Dh) @ wo

    def _B_ref(x, w1, b1, w2, b2):
        B, S, D = x.shape
        h = _layernorm(x, axis=-1)
        u = torch.einsum("bsd,sf->bdf", h, w1) + b1
        u = _gelu(u)
        y = torch.einsum("bdf,fs->bds", u, w2) + b2
        return (lambda x, *d: x.permute(*d))(y, 0, 2, 1)

    x = A_x
    x = x + _A_ref(_layernorm(x, axis=-1), A_wq, A_wk, A_wv, A_wo)
    x = x + _B_ref(_layernorm(x, axis=-1), B_w1, B_b1, B_w2, B_b2)
    x = x + _A_ref(_layernorm(x, axis=-1), A_wq, A_wk, A_wv, A_wo)
    x = x + _B_ref(_layernorm(x, axis=-1), B_w1, B_b1, B_w2, B_b2)
    return x
```

```asm
; @launch kernel=qkv0_kernel grid=(256,1,1) block=(512,1,1) lds=136704
; @launch kernel=attn0_kernel grid=(256,1,1) block=(512,1,1) lds=161792
; @launch kernel=mlp1_0_kernel grid=(216,1,1) block=(512,1,1) lds=154624
; @launch kernel=mlp2_0_kernel grid=(256,1,1) block=(768,1,1) lds=131072
; @launch kernel=qkv1_kernel grid=(256,1,1) block=(512,1,1) lds=136704
; @launch kernel=attn1_kernel grid=(256,1,1) block=(512,1,1) lds=161792
; @launch kernel=mlp1_0_kernel grid=(216,1,1) block=(512,1,1) lds=154624
; @launch kernel=mlp2_1_kernel grid=(256,1,1) block=(768,1,1) lds=131072
.amdgcn_target "amdgcn-amd-amdhsa--gfx950"
.text
.p2align 8
L_text_start:
.globl qkv1_kernel
.p2align 8
.type qkv1_kernel,@function
qkv1_kernel:
    s_mov_b32 s99, 1
    s_branch L_qkv_body
.globl qkv0_kernel
.p2align 8
.type qkv0_kernel,@function
qkv0_kernel:
    s_mov_b32 s99, 0
L_qkv_body:
    s_cmp_ge_u32 s2, 256
    s_cbranch_scc1 L_qkv0_kernel_end
    s_load_dwordx4 s[4:7], s[0:1], 0
    s_load_dwordx4 s[8:11], s[0:1], 16
    s_load_dwordx2 s[12:13], s[0:1], 96
    v_lshrrev_b32 v1, 6, v0
    v_and_b32 v0, 63, v0
    v_readfirstlane_b32 s32, v1
    s_and_b32 s33, s2, 7
    s_lshr_b32 s34, s2, 3
    s_and_b32 s34, s34, 3
    s_lshl_b32 s34, s34, 3
    s_add_u32 s33, s33, s34
    s_lshr_b32 s34, s2, 5
    s_movk_i32 s38, 1280
    s_cmp_ge_u32 s32, 4
    s_cbranch_scc1 L_qkv0_kernel_p0
    v_and_b32 v1, 15, v0
    v_lshrrev_b32 v2, 4, v0
    s_lshl_b32 s42, s32, 12
    v_lshrrev_b32 v10, 1, v1
    v_and_b32 v10, 7, v10
    v_lshrrev_b32 v11, 1, v2
    v_and_b32 v12, 1, v2
    v_lshlrev_b32 v13, 7, v1
    v_lshl_add_u32 v13, v12, 3, v13
    v_add_u32 v13, s42, v13
    v_add_u32 v13, 61440, v13
    v_add_u32 v15, 0, v11
    v_xor_b32 v15, v15, v10
    v_lshl_add_u32 v16, v15, 4, v13
    v_add_u32 v15, 2, v11
    v_xor_b32 v15, v15, v10
    v_lshl_add_u32 v17, v15, 4, v13
    v_add_u32 v15, 4, v11
    v_xor_b32 v15, v15, v10
    v_lshl_add_u32 v18, v15, 4, v13
    v_add_u32 v15, 6, v11
    v_xor_b32 v15, v15, v10
    v_lshl_add_u32 v19, v15, 4, v13
    v_lshrrev_b32 v10, 2, v1
    v_lshl_add_u32 v10, v2, 2, v10
    v_and_b32 v11, 3, v1
    v_lshlrev_b32 v11, 3, v11
    v_mul_u32_u24 v12, 160, v10
    v_add_u32 v20, v12, v11
    s_lshl_b32 s43, s32, 5
    v_add_u32 v21, s43, v20
    v_mul_u32_u24 v12, 40, v10
    v_add_u32 v12, v12, v11
    s_lshr_b32 s43, s34, 1
    s_lshl_b32 s43, s43, 5
    s_add_u32 s43, s43, 110592
    v_add_u32 v22, s43, v12
    v_mov_b32 v24, 0x3f803f80
    v_mov_b32 v25, 0x3f803f80
    v_mov_b32 v26, 0x3f803f80
    v_mov_b32 v27, 0x3f803f80
    v_mov_b32 v28, 0
    v_mov_b32 v29, 0
    v_mov_b32 v30, 0
    v_mov_b32 v31, 0
    v_mov_b32 v32, 0
    v_mov_b32 v33, 0
    v_mov_b32 v34, 0
    v_mov_b32 v35, 0
    v_mov_b32 v36, 0
    v_mov_b32 v37, 0
    v_mov_b32 v38, 0
    v_mov_b32 v39, 0
    v_mov_b32 v40, 0
    v_mov_b32 v41, 0
    v_mov_b32 v42, 0
    v_mov_b32 v43, 0
    v_mov_b32 v44, 0
    v_mov_b32 v45, 0
    v_mov_b32 v46, 0
    v_mov_b32 v47, 0
    v_mov_b32 v48, 0
    v_mov_b32 v49, 0
    v_mov_b32 v50, 0
    v_mov_b32 v51, 0
    v_mov_b32 v52, 0
    v_mov_b32 v53, 0
    v_mov_b32 v54, 0
    v_mov_b32 v55, 0
    v_mov_b32 v56, 0
    v_mov_b32 v57, 0
    v_mov_b32 v58, 0
    v_mov_b32 v59, 0
    v_mov_b32 v60, 0
    v_mov_b32 v61, 0
    v_mov_b32 v62, 0
    v_mov_b32 v63, 0
    v_mov_b32 v64, 0
    v_mov_b32 v65, 0
    v_mov_b32 v66, 0
    v_mov_b32 v67, 0
    v_mov_b32 v68, 0
    v_mov_b32 v69, 0
    v_mov_b32 v70, 0
    v_mov_b32 v71, 0
    v_mov_b32 v72, 0
    v_mov_b32 v73, 0
    v_mov_b32 v74, 0
    v_mov_b32 v75, 0
    v_mov_b32 v76, 0
    v_mov_b32 v77, 0
    v_mov_b32 v78, 0
    v_mov_b32 v79, 0
    s_waitcnt lgkmcnt(0)
    s_mov_b32 s28, s12
    s_and_b32 s29, s13, 0xffff
    s_mov_b32 s30, 0x10000000
    s_mov_b32 s31, 0x00020000
    s_cmp_ge_u32 s34, 4
    s_cbranch_scc1 L_qkv0_kernel_nokv
    s_bitcmp0_b32 s34, 0
    s_cselect_b32 s14, s8, s10
    s_cselect_b32 s15, s9, s11
    s_mov_b32 s24, s14
    s_and_b32 s25, s15, 0xffff
    s_mov_b32 s26, 0x6400
    s_mov_b32 s27, 0x00020000
    v_lshlrev_b32 v14, 4, v0
    s_lshl_b32 s43, s32, 10
L_qkv0_kernel_kvl:
    s_add_u32 s44, s43, 110592
    s_mov_b32 m0, s44
    s_nop 0
    buffer_load_dwordx4 v14, s[24:27], s43 offen lds
    s_add_u32 s43, s43, 4096
    s_cmp_lt_u32 s43, 25600
    s_cbranch_scc1 L_qkv0_kernel_kvl
    s_waitcnt vmcnt(0)
L_qkv0_kernel_nokv:
    s_cmp_lt_u32 s34, 4
    s_cselect_b64 vcc, -1, 0
    s_mov_b32 s41, 0
    s_mov_b32 s46, 16384
    s_mov_b32 s47, 20480
L_qkv0_kernel_stage:
    s_barrier
    ds_read_b64 v[80:81], v16 offset:0
    ds_read_b64 v[82:83], v17 offset:0
    ds_read_b64_tr_b16 v[84:85], v20 offset:0
    ds_read_b64_tr_b16 v[86:87], v20 offset:2560
    ds_read_b64_tr_b16 v[88:89], v20 offset:32
    ds_read_b64_tr_b16 v[90:91], v20 offset:2592
    ds_read_b64_tr_b16 v[92:93], v20 offset:64
    ds_read_b64_tr_b16 v[94:95], v20 offset:2624
    ds_read_b64_tr_b16 v[96:97], v20 offset:96
    ds_read_b64_tr_b16 v[98:99], v20 offset:2656
    ds_read_b64_tr_b16 v[100:101], v20 offset:128
    ds_read_b64_tr_b16 v[102:103], v20 offset:2688
    ds_read_b64_tr_b16 v[112:113], v21 offset:0
    ds_read_b64_tr_b16 v[114:115], v21 offset:2560
    s_cbranch_vccz L_qkv0_kernel_k0
    ds_read_b64_tr_b16 v[104:105], v22 offset:0
    ds_read_b64_tr_b16 v[106:107], v22 offset:640
L_qkv0_kernel_k0:
    s_waitcnt lgkmcnt(0)
    v_mfma_f32_16x16x32_bf16 v[28:31], v[84:87], v[80:83], v[28:31]
    ds_read_b64 v[116:117], v18 offset:0
    ds_read_b64 v[118:119], v19 offset:0
    v_mfma_f32_16x16x32_bf16 v[32:35], v[88:91], v[80:83], v[32:35]
    ds_read_b64_tr_b16 v[120:121], v20 offset:5120
    ds_read_b64_tr_b16 v[122:123], v20 offset:7680
    v_mfma_f32_16x16x32_bf16 v[36:39], v[92:95], v[80:83], v[36:39]
    ds_read_b64_tr_b16 v[124:125], v20 offset:5152
    ds_read_b64_tr_b16 v[126:127], v20 offset:7712
    v_mfma_f32_16x16x32_bf16 v[40:43], v[96:99], v[80:83], v[40:43]
    ds_read_b64_tr_b16 v[128:129], v20 offset:5184
    ds_read_b64_tr_b16 v[130:131], v20 offset:7744
    v_mfma_f32_16x16x32_bf16 v[44:47], v[100:103], v[80:83], v[44:47]
    ds_read_b64_tr_b16 v[132:133], v20 offset:5216
    ds_read_b64_tr_b16 v[134:135], v20 offset:7776
    v_mfma_f32_16x16x32_bf16 v[56:59], v[100:103], v[24:27], v[56:59]
    ds_read_b64_tr_b16 v[136:137], v20 offset:5248
    ds_read_b64_tr_b16 v[138:139], v20 offset:7808
    v_mfma_f32_16x16x32_bf16 v[68:71], v[112:115], v[24:27], v[68:71]
    ds_read_b64_tr_b16 v[148:149], v21 offset:5120
    ds_read_b64_tr_b16 v[150:151], v21 offset:7680
    v_mfma_f32_16x16x32_bf16 v[72:75], v[24:27], v[80:83], v[72:75]
    v_mfma_f32_16x16x32_bf16 v[76:79], v[80:83], v[80:83], v[76:79]
    s_cbranch_vccz L_qkv0_kernel_k1
    v_mfma_f32_16x16x32_bf16 v[48:51], v[104:107], v[80:83], v[48:51]
    ds_read_b64_tr_b16 v[140:141], v22 offset:1280
    v_mfma_f32_16x16x32_bf16 v[60:63], v[104:107], v[24:27], v[60:63]
    ds_read_b64_tr_b16 v[142:143], v22 offset:1920
L_qkv0_kernel_k1:
    s_waitcnt lgkmcnt(0)
    v_mfma_f32_16x16x32_bf16 v[28:31], v[120:123], v[116:119], v[28:31]
    ds_read_b64 v[80:81], v16 offset:2048
    ds_read_b64 v[82:83], v17 offset:2048
    v_mfma_f32_16x16x32_bf16 v[32:35], v[124:127], v[116:119], v[32:35]
    ds_read_b64_tr_b16 v[84:85], v20 offset:10240
    ds_read_b64_tr_b16 v[86:87], v20 offset:12800
    v_mfma_f32_16x16x32_bf16 v[36:39], v[128:131], v[116:119], v[36:39]
    ds_read_b64_tr_b16 v[88:89], v20 offset:10272
    ds_read_b64_tr_b16 v[90:91], v20 offset:12832
    v_mfma_f32_16x16x32_bf16 v[40:43], v[132:135], v[116:119], v[40:43]
    ds_read_b64_tr_b16 v[92:93], v20 offset:10304
    ds_read_b64_tr_b16 v[94:95], v20 offset:12864
    v_mfma_f32_16x16x32_bf16 v[44:47], v[136:139], v[116:119], v[44:47]
    ds_read_b64_tr_b16 v[96:97], v20 offset:10336
    ds_read_b64_tr_b16 v[98:99], v20 offset:12896
    v_mfma_f32_16x16x32_bf16 v[56:59], v[136:139], v[24:27], v[56:59]
    ds_read_b64_tr_b16 v[100:101], v20 offset:10368
    ds_read_b64_tr_b16 v[102:103], v20 offset:12928
    v_mfma_f32_16x16x32_bf16 v[68:71], v[148:151], v[24:27], v[68:71]
    ds_read_b64_tr_b16 v[112:113], v21 offset:10240
    ds_read_b64_tr_b16 v[114:115], v21 offset:12800
    v_mfma_f32_16x16x32_bf16 v[72:75], v[24:27], v[116:119], v[72:75]
    v_mfma_f32_16x16x32_bf16 v[76:79], v[116:119], v[116:119], v[76:79]
    s_cbranch_vccz L_qkv0_kernel_k2
    v_mfma_f32_16x16x32_bf16 v[48:51], v[140:143], v[116:119], v[48:51]
    ds_read_b64_tr_b16 v[104:105], v22 offset:2560
    v_mfma_f32_16x16x32_bf16 v[60:63], v[140:143], v[24:27], v[60:63]
    ds_read_b64_tr_b16 v[106:107], v22 offset:3200
L_qkv0_kernel_k2:
    s_waitcnt lgkmcnt(0)
    v_mfma_f32_16x16x32_bf16 v[28:31], v[84:87], v[80:83], v[28:31]
    ds_read_b64 v[116:117], v18 offset:2048
    ds_read_b64 v[118:119], v19 offset:2048
    v_mfma_f32_16x16x32_bf16 v[32:35], v[88:91], v[80:83], v[32:35]
    ds_read_b64_tr_b16 v[120:121], v20 offset:15360
    ds_read_b64_tr_b16 v[122:123], v20 offset:17920
    v_mfma_f32_16x16x32_bf16 v[36:39], v[92:95], v[80:83], v[36:39]
    ds_read_b64_tr_b16 v[124:125], v20 offset:15392
    ds_read_b64_tr_b16 v[126:127], v20 offset:17952
    v_mfma_f32_16x16x32_bf16 v[40:43], v[96:99], v[80:83], v[40:43]
    ds_read_b64_tr_b16 v[128:129], v20 offset:15424
    ds_read_b64_tr_b16 v[130:131], v20 offset:17984
    v_mfma_f32_16x16x32_bf16 v[44:47], v[100:103], v[80:83], v[44:47]
    ds_read_b64_tr_b16 v[132:133], v20 offset:15456
    ds_read_b64_tr_b16 v[134:135], v20 offset:18016
    v_mfma_f32_16x16x32_bf16 v[56:59], v[100:103], v[24:27], v[56:59]
    ds_read_b64_tr_b16 v[136:137], v20 offset:15488
    ds_read_b64_tr_b16 v[138:139], v20 offset:18048
    v_mfma_f32_16x16x32_bf16 v[68:71], v[112:115], v[24:27], v[68:71]
    ds_read_b64_tr_b16 v[148:149], v21 offset:15360
    ds_read_b64_tr_b16 v[150:151], v21 offset:17920
    v_mfma_f32_16x16x32_bf16 v[72:75], v[24:27], v[80:83], v[72:75]
    v_mfma_f32_16x16x32_bf16 v[76:79], v[80:83], v[80:83], v[76:79]
    s_cbranch_vccz L_qkv0_kernel_k3
    v_mfma_f32_16x16x32_bf16 v[48:51], v[104:107], v[80:83], v[48:51]
    ds_read_b64_tr_b16 v[140:141], v22 offset:3840
    v_mfma_f32_16x16x32_bf16 v[60:63], v[104:107], v[24:27], v[60:63]
    ds_read_b64_tr_b16 v[142:143], v22 offset:4480
L_qkv0_kernel_k3:
    s_waitcnt lgkmcnt(0)
    v_mfma_f32_16x16x32_bf16 v[28:31], v[120:123], v[116:119], v[28:31]
    v_mfma_f32_16x16x32_bf16 v[32:35], v[124:127], v[116:119], v[32:35]
    v_mfma_f32_16x16x32_bf16 v[36:39], v[128:131], v[116:119], v[36:39]
    v_mfma_f32_16x16x32_bf16 v[40:43], v[132:135], v[116:119], v[40:43]
    v_mfma_f32_16x16x32_bf16 v[44:47], v[136:139], v[116:119], v[44:47]
    v_mfma_f32_16x16x32_bf16 v[56:59], v[136:139], v[24:27], v[56:59]
    v_mfma_f32_16x16x32_bf16 v[68:71], v[148:151], v[24:27], v[68:71]
    v_mfma_f32_16x16x32_bf16 v[72:75], v[24:27], v[116:119], v[72:75]
    v_mfma_f32_16x16x32_bf16 v[76:79], v[116:119], v[116:119], v[76:79]
    s_cbranch_vccz L_qkv0_kernel_k4
    v_mfma_f32_16x16x32_bf16 v[48:51], v[140:143], v[116:119], v[48:51]
    v_mfma_f32_16x16x32_bf16 v[60:63], v[140:143], v[24:27], v[60:63]
L_qkv0_kernel_k4:
    s_cmp_eq_u32 s41, 2
    s_cselect_b32 s43, 4294934528, s46
    s_cselect_b32 s44, 4294926336, s47
    v_add_u32 v16, s43, v16
    v_add_u32 v17, s43, v17
    v_add_u32 v18, s43, v18
    v_add_u32 v19, s43, v19
    v_add_u32 v20, s44, v20
    v_add_u32 v21, s44, v21
    v_add_u32 v22, 5120, v22
    s_add_u32 s41, s41, 1
    s_cmp_lt_u32 s41, 5
    s_cbranch_scc1 L_qkv0_kernel_stage
    s_branch L_qkv0_kernel_epi
L_qkv0_kernel_p0:
    s_sub_u32 s32, s32, 4
    s_mul_i32 s36, s34, 160
    s_mov_b32 s37, 6554
    v_add_u32 v10, 0, v0
    v_mul_lo_u32 v11, v10, s37
    v_lshrrev_b32 v11, 16, v11
    v_mul_u32_u24 v12, 10, v11
    v_sub_u32 v12, v10, v12
    v_mul_lo_u32 v11, v11, s38
    v_lshl_add_u32 v11, v12, 4, v11
    v_add_u32 v11, s36, v11
    v_subrev_u32 v4, 0, v11
    v_add_u32 v10, 64, v0
    v_mul_lo_u32 v11, v10, s37
    v_lshrrev_b32 v11, 16, v11
    v_mul_u32_u24 v12, 10, v11
    v_sub_u32 v12, v10, v12
    v_mul_lo_u32 v11, v11, s38
    v_lshl_add_u32 v11, v12, 4, v11
    v_add_u32 v11, s36, v11
    v_subrev_u32 v5, 1024, v11
    v_add_u32 v10, 128, v0
    v_mul_lo_u32 v11, v10, s37
    v_lshrrev_b32 v11, 16, v11
    v_mul_u32_u24 v12, 10, v11
    v_sub_u32 v12, v10, v12
    v_mul_lo_u32 v11, v11, s38
    v_lshl_add_u32 v11, v12, 4, v11
    v_add_u32 v11, s36, v11
    v_subrev_u32 v6, 2048, v11
    v_add_u32 v10, 192, v0
    v_mul_lo_u32 v11, v10, s37
    v_lshrrev_b32 v11, 16, v11
    v_mul_u32_u24 v12, 10, v11
    v_sub_u32 v12, v10, v12
    v_mul_lo_u32 v11, v11, s38
    v_lshl_add_u32 v11, v12, 4, v11
    v_add_u32 v11, s36, v11
    v_subrev_u32 v7, 3072, v11
    v_add_u32 v10, 256, v0
    v_mul_lo_u32 v11, v10, s37
    v_lshrrev_b32 v11, 16, v11
    v_mul_u32_u24 v12, 10, v11
    v_sub_u32 v12, v10, v12
    v_mul_lo_u32 v11, v11, s38
    v_lshl_add_u32 v11, v12, 4, v11
    v_add_u32 v11, s36, v11
    v_subrev_u32 v8, 0, v11
    v_lshrrev_b32 v10, 3, v0
    v_and_b32 v11, 7, v0
    v_add_u32 v12, 0, v10
    v_lshrrev_b32 v13, 1, v12
    v_and_b32 v13, 7, v13
    v_xor_b32 v13, v13, v11
    v_mul_lo_u32 v12, v12, s38
    v_lshl_add_u32 v12, v13, 4, v12
    v_add_u32 v16, 4096, v12
    v_add_u32 v18, 2176, v12
    v_add_u32 v12, 8, v10
    v_lshrrev_b32 v13, 1, v12
    v_and_b32 v13, 7, v13
    v_xor_b32 v13, v13, v11
    v_mul_lo_u32 v12, v12, s38
    v_lshl_add_u32 v12, v13, 4, v12
    v_add_u32 v17, 3072, v12
    v_add_u32 v19, 1152, v12
    s_mul_i32 s40, s32, 40960
    s_mul_i32 s41, s32, 5120
    s_mul_i32 s42, s33, 81920
    s_mul_i32 s43, s32, 20480
    s_add_u32 s42, s42, s43
    s_lshl_b32 s43, s32, 12
    s_add_u32 s43, s43, 61440
    s_waitcnt lgkmcnt(0)
    s_mov_b32 s20, s6
    s_and_b32 s21, s7, 0xffff
    s_mov_b32 s22, 0xc8000
    s_mov_b32 s23, 0x00020000
    s_add_u32 s14, s12, 0xe00000
    s_addc_u32 s15, s13, 0
    s_cmp_eq_u32 s99, 0
    s_cselect_b32 s4, s4, s14
    s_cselect_b32 s5, s5, s15
    s_sub_u32 s4, s4, 4096
    s_subb_u32 s5, s5, 0
    s_mov_b32 s16, s4
    s_and_b32 s17, s5, 0xffff
    s_mov_b32 s18, 0x281000
    s_mov_b32 s19, 0x00020000
    s_mov_b32 m0, s43
    s_add_u32 s45, s41, 4096
    buffer_load_dwordx4 v16, s[16:19], s42 offen offset:0 lds
    buffer_load_dwordx4 v17, s[16:19], s42 offen offset:1024 lds
    buffer_load_dwordx4 v18, s[16:19], s42 offen offset:2048 lds
    buffer_load_dwordx4 v19, s[16:19], s42 offen offset:3072 lds
    s_mov_b32 m0, s41
    s_add_u32 s42, s42, 256
    buffer_load_dwordx4 v4, s[20:23], s40 offen offset:0 lds
    buffer_load_dwordx4 v5, s[20:23], s40 offen offset:1024 lds
    buffer_load_dwordx4 v6, s[20:23], s40 offen offset:2048 lds
    buffer_load_dwordx4 v7, s[20:23], s40 offen offset:3072 lds
    s_mov_b32 m0, s45
    s_add_u32 s41, s41, 20480
    buffer_load_dwordx4 v8, s[20:23], s40 offen lds
    s_add_u32 s40, s40, 163840
    s_add_u32 s43, s43, 16384
    s_cmp_lg_u32 s99, 0
    s_cbranch_scc1 L_qkv0_kernel_ncp
    s_getpc_b64 s[90:91]
L_pc_ref1:
    s_sub_u32 s90, s90, L_pc_ref1 - L_text_start
    s_subb_u32 s91, s91, 0
    s_lshr_b32 s92, s2, 3
    s_mul_i32 s92, s92, 4
    s_add_u32 s92, s92, s32
    s_lshl_b32 s92, s92, 9
    s_min_u32 s92, s92, L_text_end - L_text_start - 512
    s_add_u32 s90, s90, s92
    s_addc_u32 s91, s91, 0
    v_lshlrev_b32 v20, 3, v0
    global_load_dwordx2 v[22:23], v20, s[90:91]
L_qkv0_kernel_ncp:
    s_mov_b32 m0, s43
    s_add_u32 s45, s41, 4096
    buffer_load_dwordx4 v16, s[16:19], s42 offen offset:0 lds
    buffer_load_dwordx4 v17, s[16:19], s42 offen offset:1024 lds
    buffer_load_dwordx4 v18, s[16:19], s42 offen offset:2048 lds
    buffer_load_dwordx4 v19, s[16:19], s42 offen offset:3072 lds
    s_mov_b32 m0, s41
    s_add_u32 s42, s42, 256
    buffer_load_dwordx4 v4, s[20:23], s40 offen offset:0 lds
    buffer_load_dwordx4 v5, s[20:23], s40 offen offset:1024 lds
    buffer_load_dwordx4 v6, s[20:23], s40 offen offset:2048 lds
    buffer_load_dwordx4 v7, s[20:23], s40 offen offset:3072 lds
    s_mov_b32 m0, s45
    s_add_u32 s41, s41, 20480
    buffer_load_dwordx4 v8, s[20:23], s40 offen lds
    s_add_u32 s40, s40, 163840
    s_add_u32 s43, s43, 16384
    s_mov_b32 m0, s43
    s_add_u32 s45, s41, 4096
    buffer_load_dwordx4 v16, s[16:19], s42 offen offset:0 lds
    buffer_load_dwordx4 v17, s[16:19], s42 offen offset:1024 lds
    buffer_load_dwordx4 v18, s[16:19], s42 offen offset:2048 lds
    buffer_load_dwordx4 v19, s[16:19], s42 offen offset:3072 lds
    s_mov_b32 m0, s41
    s_add_u32 s42, s42, 256
    buffer_load_dwordx4 v4, s[20:23], s40 offen offset:0 lds
    buffer_load_dwordx4 v5, s[20:23], s40 offen offset:1024 lds
    buffer_load_dwordx4 v6, s[20:23], s40 offen offset:2048 lds
    buffer_load_dwordx4 v7, s[20:23], s40 offen offset:3072 lds
    s_mov_b32 m0, s45
    s_add_u32 s41, s41, 20480
    buffer_load_dwordx4 v8, s[20:23], s40 offen lds
    s_add_u32 s40, s40, 163840
    s_add_u32 s43, s43, 16384
    s_sub_u32 s41, s41, 61440
    s_sub_u32 s43, s43, 49152
    s_waitcnt vmcnt(18)
    s_barrier
    s_waitcnt vmcnt(9)
    s_barrier
    s_mov_b32 m0, s43
    s_add_u32 s45, s41, 4096
    buffer_load_dwordx4 v16, s[16:19], s42 offen offset:0 lds
    buffer_load_dwordx4 v17, s[16:19], s42 offen offset:1024 lds
    buffer_load_dwordx4 v18, s[16:19], s42 offen offset:2048 lds
    buffer_load_dwordx4 v19, s[16:19], s42 offen offset:3072 lds
    s_mov_b32 m0, s41
    s_add_u32 s42, s42, 256
    buffer_load_dwordx4 v4, s[20:23], s40 offen offset:0 lds
    buffer_load_dwordx4 v5, s[20:23], s40 offen offset:1024 lds
    buffer_load_dwordx4 v6, s[20:23], s40 offen offset:2048 lds
    buffer_load_dwordx4 v7, s[20:23], s40 offen offset:3072 lds
    s_mov_b32 m0, s45
    s_add_u32 s41, s41, 20480
    buffer_load_dwordx4 v8, s[20:23], s40 offen lds
    s_add_u32 s40, s40, 163840
    s_add_u32 s43, s43, 16384
    s_waitcnt vmcnt(9)
    s_barrier
    s_mov_b32 m0, s43
    s_add_u32 s45, s41, 4096
    buffer_load_dwordx4 v16, s[16:19], s42 offen offset:0 lds
    buffer_load_dwordx4 v17, s[16:19], s42 offen offset:1024 lds
    buffer_load_dwordx4 v18, s[16:19], s42 offen offset:2048 lds
    buffer_load_dwordx4 v19, s[16:19], s42 offen offset:3072 lds
    s_mov_b32 m0, s41
    s_add_u32 s42, s42, 256
    buffer_load_dwordx4 v4, s[20:23], s40 offen offset:0 lds
    buffer_load_dwordx4 v5, s[20:23], s40 offen offset:1024 lds
    buffer_load_dwordx4 v6, s[20:23], s40 offen offset:2048 lds
    buffer_load_dwordx4 v7, s[20:23], s40 offen offset:3072 lds
    s_mov_b32 m0, s45
    s_add_u32 s41, s41, 20480
    buffer_load_dwordx4 v8, s[20:23], s40 offen lds
    s_add_u32 s40, s40, 163840
    s_add_u32 s43, s43, 16384
    s_waitcnt vmcnt(9)
    s_barrier
    s_waitcnt vmcnt(0)
    s_barrier
    s_barrier
    s_branch L_qkv0_kernel_end
L_qkv0_kernel_epi:
    s_nop 7
    s_nop 7
    v_lshlrev_b32 v10, 4, v2
    s_lshl_b32 s43, s32, 6
    s_add_u32 s43, s43, 136192
    v_add_u32 v11, s43, v10
    v_cmp_eq_u32 vcc, 0, v1
    s_and_saveexec_b64 s[46:47], vcc
    ds_write_b128 v11, v[68:71]
    s_mov_b64 exec, s[46:47]
    v_and_b32 v12, 3, v1
    v_mov_b32 v13, v76
    v_cmp_eq_u32 vcc, 1, v12
    s_nop 1
    v_cndmask_b32 v13, v13, v77, vcc
    v_cmp_eq_u32 vcc, 2, v12
    s_nop 1
    v_cndmask_b32 v13, v13, v78, vcc
    v_cmp_eq_u32 vcc, 3, v12
    s_nop 1
    v_cndmask_b32 v13, v13, v79, vcc
    v_lshrrev_b32 v12, 2, v1
    v_lshl_add_u32 v12, v12, 4, v1
    v_lshlrev_b32 v12, 2, v12
    ds_bpermute_b32 v13, v12, v13
    s_waitcnt lgkmcnt(0)
    s_barrier
    v_add_u32 v11, 136192, v10
    ds_read_b128 v[80:83], v11 offset:0
    ds_read_b128 v[84:87], v11 offset:64
    ds_read_b128 v[88:91], v11 offset:128
    ds_read_b128 v[92:95], v11 offset:192
    s_mov_b32 s43, 0x3acccccd
    v_mul_f32 v14, s43, v72
    v_mul_f32 v13, s43, v13
    v_fma_f32 v13, -v14, v14, v13
    v_max_f32 v13, 0, v13
    v_add_f32 v13, 0x3727c5ac, v13
    v_rsq_f32 v15, v13
    s_nop 0
    v_mul_f32 v23, 0x3ea52b5c, v15
    s_waitcnt lgkmcnt(0)
    s_lshl_b32 s43, s33, 2
    s_add_u32 s43, s43, s32
    s_mul_i32 s44, s43, 20480
    s_mul_i32 s45, s34, 2560
    s_add_u32 s44, s44, s45
    s_add_u32 s44, s44, 0
    v_lshlrev_b32 v10, 3, v0
    v_fma_f32 v96, -v14, v80, v28
    v_mul_f32 v96, v23, v96
    v_fma_f32 v97, -v14, v81, v29
    v_mul_f32 v97, v23, v97
    v_fma_f32 v98, -v14, v82, v30
    v_mul_f32 v98, v23, v98
    v_fma_f32 v99, -v14, v83, v31
    v_mul_f32 v99, v23, v99
    v_cvt_pk_bf16_f32 v100, v96, v97
    v_cvt_pk_bf16_f32 v101, v98, v99
    buffer_store_dwordx2 v[100:101], v10, s[28:31], s44 offen offset:0
    v_fma_f32 v96, -v14, v84, v32
    v_mul_f32 v96, v23, v96
    v_fma_f32 v97, -v14, v85, v33
    v_mul_f32 v97, v23, v97
    v_fma_f32 v98, -v14, v86, v34
    v_mul_f32 v98, v23, v98
    v_fma_f32 v99, -v14, v87, v35
    v_mul_f32 v99, v23, v99
    v_cvt_pk_bf16_f32 v102, v96, v97
    v_cvt_pk_bf16_f32 v103, v98, v99
    buffer_store_dwordx2 v[102:103], v10, s[28:31], s44 offen offset:512
    v_fma_f32 v96, -v14, v88, v36
    v_mul_f32 v96, v23, v96
    v_fma_f32 v97, -v14, v89, v37
    v_mul_f32 v97, v23, v97
    v_fma_f32 v98, -v14, v90, v38
    v_mul_f32 v98, v23, v98
    v_fma_f32 v99, -v14, v91, v39
    v_mul_f32 v99, v23, v99
    v_cvt_pk_bf16_f32 v104, v96, v97
    v_cvt_pk_bf16_f32 v105, v98, v99
    buffer_store_dwordx2 v[104:105], v10, s[28:31], s44 offen offset:1024
    v_fma_f32 v96, -v14, v92, v40
    v_mul_f32 v96, v23, v96
    v_fma_f32 v97, -v14, v93, v41
    v_mul_f32 v97, v23, v97
    v_fma_f32 v98, -v14, v94, v42
    v_mul_f32 v98, v23, v98
    v_fma_f32 v99, -v14, v95, v43
    v_mul_f32 v99, v23, v99
    v_cvt_pk_bf16_f32 v106, v96, v97
    v_cvt_pk_bf16_f32 v107, v98, v99
    buffer_store_dwordx2 v[106:107], v10, s[28:31], s44 offen offset:1536
    v_fma_f32 v96, -v14, v56, v44
    v_mul_f32 v96, v23, v96
    v_fma_f32 v97, -v14, v57, v45
    v_mul_f32 v97, v23, v97
    v_fma_f32 v98, -v14, v58, v46
    v_mul_f32 v98, v23, v98
    v_fma_f32 v99, -v14, v59, v47
    v_mul_f32 v99, v23, v99
    v_cvt_pk_bf16_f32 v108, v96, v97
    v_cvt_pk_bf16_f32 v109, v98, v99
    buffer_store_dwordx2 v[108:109], v10, s[28:31], s44 offen offset:2048
    s_cmp_lg_u32 s32, 0
    s_cbranch_scc1 L_qkv0_kernel_nozero
    v_cmp_gt_u32 vcc, 16, v0
    s_and_saveexec_b64 s[46:47], vcc
    v_mov_b32 v11, 0
    v_lshlrev_b32 v12, 2, v0
    s_lshl_b32 s45, s2, 6
    s_add_u32 s45, s45, 10485760
    buffer_store_dword v11, v12, s[28:31], s45 offen
    s_and_b32 s45, s2, 63
    s_lshl_b32 s45, s45, 8
    s_add_u32 s45, s45, 11010048
    buffer_store_dword v11, v12, s[28:31], s45 offen
    s_mov_b64 exec, s[46:47]
L_qkv0_kernel_nozero:
    s_cmp_ge_u32 s34, 4
    s_cbranch_scc1 L_qkv0_kernel_fin
    v_fma_f32 v96, -v14, v60, v48
    v_mul_f32 v96, v15, v96
    v_fma_f32 v97, -v14, v61, v49
    v_mul_f32 v97, v15, v97
    v_fma_f32 v98, -v14, v62, v50
    v_mul_f32 v98, v15, v98
    v_fma_f32 v99, -v14, v63, v51
    v_mul_f32 v99, v15, v99
    s_lshl_b32 s43, s33, 1
    s_lshr_b32 s44, s32, 1
    s_add_u32 s43, s43, s44
    s_mul_i32 s43, s43, 2688
    s_add_u32 s43, s43, 3145728
    s_and_b32 s44, s32, 1
    s_bitcmp1_b32 s34, 0
    s_cbranch_scc1 L_qkv0_kernel_vstore
    v_cvt_pk_bf16_f32 v104, v96, v97
    v_cvt_pk_bf16_f32 v105, v98, v99
    s_lshl_b32 s45, s44, 4
    v_add_u32 v10, s45, v1
    s_cmp_lg_u32 s34, 0
    s_cbranch_scc1 L_qkv0_kernel_kst2
    v_lshrrev_b32 v11, 1, v2
    v_lshlrev_b32 v11, 9, v11
    v_lshl_add_u32 v11, v10, 4, v11
    v_and_b32 v12, 1, v2
    v_lshl_add_u32 v11, v12, 3, v11
    buffer_store_dwordx2 v[104:105], v11, s[28:31], s43 offen
    s_branch L_qkv0_kernel_fin
L_qkv0_kernel_kst2:
    v_lshlrev_b32 v11, 2, v10
    v_cmp_eq_u32 vcc, 0, v2
    s_and_saveexec_b64 s[46:47], vcc
    buffer_store_dword v104, v11, s[28:31], s43 offen offset:1024
    buffer_store_dword v105, v11, s[28:31], s43 offen offset:1152
    s_mov_b64 exec, s[46:47]
    s_branch L_qkv0_kernel_fin
L_qkv0_kernel_vstore:
    v_cvt_pk_bf16_f32 v104, v96, v96
    v_cvt_pk_bf16_f32 v105, v97, v97
    v_cvt_pk_bf16_f32 v106, v98, v98
    v_cvt_pk_bf16_f32 v107, v99, v99
    s_mul_i32 s45, s44, 704
    s_add_u32 s43, s43, s45
    v_lshrrev_b32 v10, 3, v1
    v_lshlrev_b32 v10, 2, v10
    v_and_b32 v11, 3, v1
    v_add_u32 v10, v10, v11
    v_lshlrev_b32 v10, 1, v10
    v_bfe_u32 v11, v1, 2, 1
    v_mul_u32_u24 v11, 352, v11
    v_add_u32 v10, v10, v11
    s_cmp_lg_u32 s34, 1
    s_cbranch_scc1 L_qkv0_kernel_v2
    v_lshl_add_u32 v11, v2, 6, v10
    buffer_store_short v104, v11, s[28:31], s43 offen offset:1280
    buffer_store_short v105, v11, s[28:31], s43 offen offset:1296
    buffer_store_short v106, v11, s[28:31], s43 offen offset:1312
    buffer_store_short v107, v11, s[28:31], s43 offen offset:1328
    s_branch L_qkv0_kernel_fin
L_qkv0_kernel_v2:
    v_cmp_eq_u32 vcc, 0, v2
    s_and_saveexec_b64 s[46:47], vcc
    buffer_store_short v104, v10, s[28:31], s43 offen offset:1536
    buffer_store_short v105, v10, s[28:31], s43 offen offset:1552
    buffer_store_short v106, v10, s[28:31], s43 offen offset:1568
    buffer_store_short v107, v10, s[28:31], s43 offen offset:1584
    buffer_store_short v24, v10, s[28:31], s43 offen offset:1600
    v_mov_b32 v11, 0
    buffer_store_short v11, v10, s[28:31], s43 offen offset:1616
    s_mov_b64 exec, s[46:47]
L_qkv0_kernel_fin:
L_qkv0_kernel_end:
    s_endpgm
.globl attn1_kernel
.p2align 8
.type attn1_kernel,@function
attn1_kernel:
    s_mov_b32 s99, 1
    s_branch L_attn_body
.globl attn0_kernel
.p2align 8
.type attn0_kernel,@function
attn0_kernel:
    s_mov_b32 s99, 0
L_attn_body:
    s_cmp_ge_u32 s2, 256
    s_cbranch_scc1 L_attn0_kernel_end
    s_load_dwordx2 s[12:13], s[0:1], 96
    s_load_dwordx2 s[14:15], s[0:1], 32
    s_load_dwordx2 s[16:17], s[0:1], 48
    v_lshrrev_b32 v1, 6, v0
    v_and_b32 v0, 63, v0
    v_readfirstlane_b32 s32, v1
    s_and_b32 s33, s2, 7
    s_lshr_b32 s34, s2, 3
    s_and_b32 s34, s34, 3
    s_lshl_b32 s34, s34, 3
    s_add_u32 s33, s33, s34
    s_lshl_b32 s33, s33, 6
    s_lshr_b32 s34, s2, 5
    s_lshl_b32 s34, s34, 3
    s_add_u32 s33, s33, s34
    v_lshlrev_b32 v3, 4, v0
    v_lshrrev_b32 v4, 2, v0
    v_lshlrev_b32 v4, 7, v4
    v_and_b32 v5, 3, v0
    v_lshl_add_u32 v4, v5, 4, v4
    s_lshr_b32 s34, s33, 4
    s_mul_i32 s34, s34, 20480
    s_and_b32 s35, s33, 15
    s_lshl_b32 s36, s35, 3
    s_add_u32 s34, s34, s36
    s_add_u32 s34, s34, 0
    s_lshl_b32 s36, s32, 11
    s_add_u32 s36, s36, s34
    s_lshl_b32 s37, s32, 10
    s_add_u32 s37, s37, 150528
    s_lshl_b32 s50, s32, 10
    s_waitcnt lgkmcnt(0)
    s_mov_b32 s28, s12
    s_and_b32 s29, s13, 0xffff
    s_mov_b32 s30, 0x10000000
    s_mov_b32 s31, 0x00020000
    s_mov_b32 m0, s37
    s_add_u32 s33, s33, s32
    buffer_load_dwordx4 v4, s[28:31], s36 offen lds
    s_cmp_ge_u32 s32, 2
    s_cbranch_scc1 L_attn0_kernel_q1
    s_add_u32 s37, s37, 8192
    s_mov_b32 m0, s37
    s_add_u32 s36, s36, 16384
    buffer_load_dwordx4 v4, s[28:31], s36 offen lds
L_attn0_kernel_q1:
    s_mov_b32 s40, 0
    s_min_u32 s43, s50, 160768
    s_mov_b32 m0, s43
    s_add_u32 s43, s43, 3145728
    buffer_load_dwordx4 v3, s[28:31], s43 offen lds
    s_add_u32 s50, s50, 8192
    s_min_u32 s43, s50, 160768
    s_mov_b32 m0, s43
    s_add_u32 s43, s43, 3145728
    buffer_load_dwordx4 v3, s[28:31], s43 offen lds
    s_add_u32 s50, s50, 8192
    s_min_u32 s43, s50, 160768
    s_mov_b32 m0, s43
    s_add_u32 s43, s43, 3145728
    buffer_load_dwordx4 v3, s[28:31], s43 offen lds
    s_add_u32 s50, s50, 8192
    s_min_u32 s43, s50, 160768
    s_mov_b32 m0, s43
    s_add_u32 s43, s43, 3145728
    buffer_load_dwordx4 v3, s[28:31], s43 offen lds
    s_add_u32 s50, s50, 8192
    s_min_u32 s43, s50, 160768
    s_mov_b32 m0, s43
    s_add_u32 s43, s43, 3145728
    buffer_load_dwordx4 v3, s[28:31], s43 offen lds
    s_add_u32 s50, s50, 8192
    s_min_u32 s43, s50, 160768
    s_mov_b32 m0, s43
    s_add_u32 s43, s43, 3145728
    buffer_load_dwordx4 v3, s[28:31], s43 offen lds
    s_add_u32 s50, s50, 8192
    s_and_b32 s35, s33, 15
    s_mov_b32 s20, s14
    s_and_b32 s21, s15, 0xffff
    s_mov_b32 s22, 0xc8000
    s_mov_b32 s23, 0x00020000
    s_mov_b32 s24, s16
    s_and_b32 s25, s17, 0xffff
    s_mov_b32 s26, 0x6c0000
    s_mov_b32 s27, 0x00020000
    s_lshr_b32 s54, s2, 3
    s_lshl_b32 s54, s54, 3
    s_add_u32 s54, s54, s32
    s_mul_i32 s55, s54, 3200
    s_and_b32 s56, s2, 7
    s_mul_i32 s56, s56, 27
    s_lshr_b32 s56, s56, 3
    s_lshl_b32 s56, s56, 7
    s_mul_i32 s57, s54, 27648
    s_add_u32 s56, s56, s57
    v_lshrrev_b32 v4, 3, v0
    v_mul_u32_u24 v4, 3456, v4
    v_and_b32 v5, 7, v0
    v_lshl_add_u32 v136, v5, 4, v4
    v_and_b32 v1, 31, v0
    v_lshrrev_b32 v2, 5, v0
    v_mov_b32 v13, 0
    v_mov_b32 v14, 0
    v_mov_b32 v15, 0
    v_mov_b32 v101, 0
    v_mov_b32 v102, 0
    v_mov_b32 v103, 0
    v_mov_b32 v109, 0
    v_mov_b32 v110, 0
    v_mov_b32 v111, 0
    v_mov_b32 v149, 0
    v_mov_b32 v150, 0
    v_mov_b32 v151, 0
    v_mov_b32 v165, 0
    v_mov_b32 v166, 0
    v_mov_b32 v167, 0
    v_mov_b32 v181, 0
    v_mov_b32 v182, 0
    v_mov_b32 v183, 0
    v_mov_b32 v197, 0
    v_mov_b32 v198, 0
    v_mov_b32 v199, 0
    v_min_u32 v4, 21, v1
    v_lshlrev_b32 v4, 4, v4
    v_mul_u32_u24 v5, 352, v2
    v_add_u32 v4, v4, v5
    v_add_u32 v134, 1280, v4
    v_lshlrev_b32 v135, 2, v0
    v_add_u32 v135, 1024, v135
    v_mul_u32_u24 v4, 5, v1
    v_lshl_add_u32 v5, v2, 1, v4
    v_lshlrev_b32 v5, 6, v5
    s_lshl_b32 s36, s32, 3
    s_add_u32 s36, s36, 150528
    v_add_u32 v5, s36, v5
    v_add_u32 v6, 4, v4
    v_lshlrev_b32 v6, 6, v6
    v_lshl_add_u32 v6, v2, 2, v6
    v_add_u32 v6, s36, v6
    s_waitcnt vmcnt(4) lgkmcnt(0)
    s_barrier
    ds_read_b64 v[8:9], v5
    ds_read_b64 v[10:11], v5 offset:64
    ds_read_b32 v12, v6
    ds_read_b128 v[96:99], v3
    ds_read_b32 v100, v135
    s_waitcnt lgkmcnt(0)
    v_mfma_f32_32x32x16_bf16 v[32:47], v[96:99], v[8:11], 0
    v_mfma_f32_32x32x16_bf16 v[32:47], v[100:103], v[12:15], v[32:47]
    s_nop 15
    s_nop 3
    v_max_f32 v7, v32, v33
    v_max3_f32 v7, v7, v34, v35
    v_max3_f32 v7, v7, v36, v37
    v_max3_f32 v7, v7, v38, v39
    v_max3_f32 v7, v7, v40, v41
    v_max3_f32 v7, v7, v42, v43
    v_max3_f32 v7, v7, v44, v45
    v_max3_f32 v7, v7, v46, v47
L_attn0_kernel_havemax:
    v_mov_b32 v4, v7
    v_mov_b32 v5, v7
    s_nop 1
    v_permlane32_swap_b32 v4, v5
    s_nop 1
    v_max_f32 v7, v4, v5
    v_sub_f32 v7, 0, v7
    v_mov_b32 v16, v7
    v_mov_b32 v17, v7
    v_mov_b32 v18, v7
    v_mov_b32 v19, v7
    v_mov_b32 v20, v7
    v_mov_b32 v21, v7
    v_mov_b32 v22, v7
    v_mov_b32 v23, v7
    v_mov_b32 v24, v7
    v_mov_b32 v25, v7
    v_mov_b32 v26, v7
    v_mov_b32 v27, v7
    v_mov_b32 v28, v7
    v_mov_b32 v29, v7
    v_mov_b32 v30, v7
    v_mov_b32 v31, v7
    v_mov_b32 v64, 0
    v_mov_b32 v65, 0
    v_mov_b32 v66, 0
    v_mov_b32 v67, 0
    v_mov_b32 v68, 0
    v_mov_b32 v69, 0
    v_mov_b32 v70, 0
    v_mov_b32 v71, 0
    v_mov_b32 v72, 0
    v_mov_b32 v73, 0
    v_mov_b32 v74, 0
    v_mov_b32 v75, 0
    v_mov_b32 v76, 0
    v_mov_b32 v77, 0
    v_mov_b32 v78, 0
    v_mov_b32 v79, 0
    v_mov_b32 v88, 0
    v_mov_b32 v89, 0
    v_mov_b32 v90, 0
    v_mov_b32 v91, 0
    v_mov_b32 v92, 0
    v_mov_b32 v93, 0
    v_mov_b32 v94, 0
    v_mov_b32 v95, 0
    v_mov_b32 v120, 0
    v_mov_b32 v121, 0
    v_mov_b32 v122, 0
    v_mov_b32 v123, 0
    v_mov_b32 v124, 0
    v_mov_b32 v125, 0
    v_mov_b32 v126, 0
    v_mov_b32 v127, 0
    v_mov_b32 v128, v3
    v_mov_b32 v129, v135
    v_mov_b32 v130, v134
    ds_read_b128 v[96:99], v128
    ds_read_b32 v100, v129
    ds_read_b128 v[104:107], v128 offset:2688
    ds_read_b32 v108, v129 offset:2688
    s_waitcnt lgkmcnt(2)
    v_mfma_f32_32x32x16_bf16 v[32:47], v[96:99], v[8:11], v[16:31]
    v_mfma_f32_32x32x16_bf16 v[32:47], v[100:103], v[12:15], v[32:47]
    s_mov_b32 s41, 0
    s_mov_b32 s42, 0
L_attn0_kernel_chunk:
    s_cmp_lg_u32 s41, 0
    s_cbranch_scc1 L_attn0_kernel_sk0
    s_min_u32 s43, s50, 160768
    s_mov_b32 m0, s43
    s_add_u32 s43, s43, 3145728
    buffer_load_dwordx4 v3, s[28:31], s43 offen lds
    s_add_u32 s50, s50, 8192
    s_min_u32 s43, s50, 160768
    s_mov_b32 m0, s43
    s_add_u32 s43, s43, 3145728
    buffer_load_dwordx4 v3, s[28:31], s43 offen lds
    s_add_u32 s50, s50, 8192
    s_min_u32 s43, s50, 160768
    s_mov_b32 m0, s43
    s_add_u32 s43, s43, 3145728
    buffer_load_dwordx4 v3, s[28:31], s43 offen lds
    s_add_u32 s50, s50, 8192
    s_min_u32 s43, s50, 160768
    s_mov_b32 m0, s43
    s_add_u32 s43, s43, 3145728
    buffer_load_dwordx4 v3, s[28:31], s43 offen lds
    s_add_u32 s50, s50, 8192
L_attn0_kernel_sk0:
    s_cmp_lt_u32 s32, 4
    s_cbranch_scc1 L_attn0_kernel_np
    s_setprio 1
L_attn0_kernel_np:
    s_waitcnt lgkmcnt(0)
    v_mfma_f32_32x32x16_bf16 v[48:63], v[104:107], v[8:11], v[16:31]
    ds_read_b128 v[96:99], v128 offset:5376
    ds_read_b32 v100, v129 offset:5376
    v_exp_f32 v32, v32
    v_exp_f32 v33, v33
    v_exp_f32 v34, v34
    v_exp_f32 v35, v35
    v_mfma_f32_32x32x16_bf16 v[64:79], v[120:123], v[88:91], v[64:79]
    ds_read_b128 v[112:115], v130 offset:0
    ds_read_b128 v[116:119], v130 offset:704
    v_exp_f32 v36, v36
    v_exp_f32 v37, v37
    v_exp_f32 v38, v38
    v_exp_f32 v39, v39
    v_cvt_pk_bf16_f32 v80, v32, v33
    v_cvt_pk_bf16_f32 v81, v34, v35
    v_cvt_pk_bf16_f32 v82, v36, v37
    v_cvt_pk_bf16_f32 v83, v38, v39
    v_mfma_f32_32x32x16_bf16 v[48:63], v[108:111], v[12:15], v[48:63]
    v_exp_f32 v40, v40
    v_exp_f32 v41, v41
    v_exp_f32 v42, v42
    v_exp_f32 v43, v43
    v_mfma_f32_32x32x16_bf16 v[64:79], v[124:127], v[92:95], v[64:79]
    v_exp_f32 v44, v44
    v_exp_f32 v45, v45
    v_exp_f32 v46, v46
    v_exp_f32 v47, v47
    v_cvt_pk_bf16_f32 v84, v40, v41
    v_cvt_pk_bf16_f32 v85, v42, v43
    v_cvt_pk_bf16_f32 v86, v44, v45
    v_cvt_pk_bf16_f32 v87, v46, v47
    s_waitcnt lgkmcnt(0)
    v_mfma_f32_32x32x16_bf16 v[32:47], v[96:99], v[8:11], v[16:31]
    ds_read_b128 v[104:107], v128 offset:8064
    ds_read_b32 v108, v129 offset:8064
    v_exp_f32 v48, v48
    v_exp_f32 v49, v49
    v_exp_f32 v50, v50
    v_exp_f32 v51, v51
    v_mfma_f32_32x32x16_bf16 v[64:79], v[112:115], v[80:83], v[64:79]
    ds_read_b128 v[120:123], v130 offset:2688
    ds_read_b128 v[124:127], v130 offset:3392
    v_exp_f32 v52, v52
    v_exp_f32 v53, v53
    v_exp_f32 v54, v54
    v_exp_f32 v55, v55
    v_cvt_pk_bf16_f32 v88, v48, v49
    v_cvt_pk_bf16_f32 v89, v50, v51
    v_cvt_pk_bf16_f32 v90, v52, v53
    v_cvt_pk_bf16_f32 v91, v54, v55
    v_mfma_f32_32x32x16_bf16 v[32:47], v[100:103], v[12:15], v[32:47]
    v_exp_f32 v56, v56
    v_exp_f32 v57, v57
    v_exp_f32 v58, v58
    v_exp_f32 v59, v59
    v_mfma_f32_32x32x16_bf16 v[64:79], v[116:119], v[84:87], v[64:79]
    v_exp_f32 v60, v60
    v_exp_f32 v61, v61
    v_exp_f32 v62, v62
    v_exp_f32 v63, v63
    v_cvt_pk_bf16_f32 v92, v56, v57
    v_cvt_pk_bf16_f32 v93, v58, v59
    v_cvt_pk_bf16_f32 v94, v60, v61
    v_cvt_pk_bf16_f32 v95, v62, v63
    s_cmp_lg_u32 s41, 1
    s_cbranch_scc1 L_attn0_kernel_pf2
    s_mov_b32 s43, 3307008
    buffer_load_dwordx4 v[144:147], v3, s[28:31], s43 offen
    buffer_load_dword v148, v135, s[28:31], s43 offen
    buffer_load_dwordx4 v[152:155], v134, s[28:31], s43 offen
    buffer_load_dwordx4 v[156:159], v134, s[28:31], s43 offen offset:704
    s_mov_b32 s43, 3309696
    buffer_load_dwordx4 v[160:163], v3, s[28:31], s43 offen
    buffer_load_dword v164, v135, s[28:31], s43 offen
    buffer_load_dwordx4 v[168:171], v134, s[28:31], s43 offen
    buffer_load_dwordx4 v[172:175], v134, s[28:31], s43 offen offset:704
    s_mov_b32 s43, 3312384
    buffer_load_dwordx4 v[176:179], v3, s[28:31], s43 offen
    buffer_load_dword v180, v135, s[28:31], s43 offen
    buffer_load_dwordx4 v[184:187], v134, s[28:31], s43 offen
    buffer_load_dwordx4 v[188:191], v134, s[28:31], s43 offen offset:704
    s_mov_b32 s43, 3315072
    buffer_load_dwordx4 v[192:195], v3, s[28:31], s43 offen
    buffer_load_dword v196, v135, s[28:31], s43 offen
    buffer_load_dwordx4 v[200:203], v134, s[28:31], s43 offen
    buffer_load_dwordx4 v[204:207], v134, s[28:31], s43 offen offset:704
L_attn0_kernel_pf2:
    s_waitcnt lgkmcnt(0)
    v_mfma_f32_32x32x16_bf16 v[48:63], v[104:107], v[8:11], v[16:31]
    ds_read_b128 v[96:99], v128 offset:10752
    ds_read_b32 v100, v129 offset:10752
    v_exp_f32 v32, v32
    v_exp_f32 v33, v33
    v_exp_f32 v34, v34
    v_exp_f32 v35, v35
    v_mfma_f32_32x32x16_bf16 v[64:79], v[120:123], v[88:91], v[64:79]
    ds_read_b128 v[112:115], v130 offset:5376
    ds_read_b128 v[116:119], v130 offset:6080
    v_exp_f32 v36, v36
    v_exp_f32 v37, v37
    v_exp_f32 v38, v38
    v_exp_f32 v39, v39
    v_cvt_pk_bf16_f32 v80, v32, v33
    v_cvt_pk_bf16_f32 v81, v34, v35
    v_cvt_pk_bf16_f32 v82, v36, v37
    v_cvt_pk_bf16_f32 v83, v38, v39
    v_mfma_f32_32x32x16_bf16 v[48:63], v[108:111], v[12:15], v[48:63]
    v_exp_f32 v40, v40
    v_exp_f32 v41, v41
    v_exp_f32 v42, v42
    v_exp_f32 v43, v43
    v_mfma_f32_32x32x16_bf16 v[64:79], v[124:127], v[92:95], v[64:79]
    v_exp_f32 v44, v44
    v_exp_f32 v45, v45
    v_exp_f32 v46, v46
    v_exp_f32 v47, v47
    v_cvt_pk_bf16_f32 v84, v40, v41
    v_cvt_pk_bf16_f32 v85, v42, v43
    v_cvt_pk_bf16_f32 v86, v44, v45
    v_cvt_pk_bf16_f32 v87, v46, v47
    s_waitcnt lgkmcnt(0)
    v_mfma_f32_32x32x16_bf16 v[32:47], v[96:99], v[8:11], v[16:31]
    ds_read_b128 v[104:107], v128 offset:13440
    ds_read_b32 v108, v129 offset:13440
    v_exp_f32 v48, v48
    v_exp_f32 v49, v49
    v_exp_f32 v50, v50
    v_exp_f32 v51, v51
    v_mfma_f32_32x32x16_bf16 v[64:79], v[112:115], v[80:83], v[64:79]
    ds_read_b128 v[120:123], v130 offset:8064
    ds_read_b128 v[124:127], v130 offset:8768
    v_exp_f32 v52, v52
    v_exp_f32 v53, v53
    v_exp_f32 v54, v54
    v_exp_f32 v55, v55
    v_cvt_pk_bf16_f32 v88, v48, v49
    v_cvt_pk_bf16_f32 v89, v50, v51
    v_cvt_pk_bf16_f32 v90, v52, v53
    v_cvt_pk_bf16_f32 v91, v54, v55
    v_mfma_f32_32x32x16_bf16 v[32:47], v[100:103], v[12:15], v[32:47]
    v_exp_f32 v56, v56
    v_exp_f32 v57, v57
    v_exp_f32 v58, v58
    v_exp_f32 v59, v59
    v_mfma_f32_32x32x16_bf16 v[64:79], v[116:119], v[84:87], v[64:79]
    v_exp_f32 v60, v60
    v_exp_f32 v61, v61
    v_exp_f32 v62, v62
    v_exp_f32 v63, v63
    v_cvt_pk_bf16_f32 v92, v56, v57
    v_cvt_pk_bf16_f32 v93, v58, v59
    v_cvt_pk_bf16_f32 v94, v60, v61
    v_cvt_pk_bf16_f32 v95, v62, v63
    s_cmp_lg_u32 s41, 0
    s_cbranch_scc1 L_attn0_kernel_nb4
    s_waitcnt vmcnt(4)
    s_barrier
L_attn0_kernel_nb4:
    s_waitcnt lgkmcnt(0)
    v_mfma_f32_32x32x16_bf16 v[48:63], v[104:107], v[8:11], v[16:31]
    ds_read_b128 v[96:99], v128 offset:16128
    ds_read_b32 v100, v129 offset:16128
    v_exp_f32 v32, v32
    v_exp_f32 v33, v33
    v_exp_f32 v34, v34
    v_exp_f32 v35, v35
    v_mfma_f32_32x32x16_bf16 v[64:79], v[120:123], v[88:91], v[64:79]
    ds_read_b128 v[112:115], v130 offset:10752
    ds_read_b128 v[116:119], v130 offset:11456
    v_exp_f32 v36, v36
    v_exp_f32 v37, v37
    v_exp_f32 v38, v38
    v_exp_f32 v39, v39
    v_cvt_pk_bf16_f32 v80, v32, v33
    v_cvt_pk_bf16_f32 v81, v34, v35
    v_cvt_pk_bf16_f32 v82, v36, v37
    v_cvt_pk_bf16_f32 v83, v38, v39
    v_mfma_f32_32x32x16_bf16 v[48:63], v[108:111], v[12:15], v[48:63]
    v_exp_f32 v40, v40
    v_exp_f32 v41, v41
    v_exp_f32 v42, v42
    v_exp_f32 v43, v43
    v_mfma_f32_32x32x16_bf16 v[64:79], v[124:127], v[92:95], v[64:79]
    v_exp_f32 v44, v44
    v_exp_f32 v45, v45
    v_exp_f32 v46, v46
    v_exp_f32 v47, v47
    v_cvt_pk_bf16_f32 v84, v40, v41
    v_cvt_pk_bf16_f32 v85, v42, v43
    v_cvt_pk_bf16_f32 v86, v44, v45
    v_cvt_pk_bf16_f32 v87, v46, v47
    s_cmp_lg_u32 s41, 0
    s_cbranch_scc1 L_attn0_kernel_sk5
    s_min_u32 s43, s50, 160768
    s_mov_b32 m0, s43
    s_add_u32 s43, s43, 3145728
    buffer_load_dwordx4 v3, s[28:31], s43 offen lds
    s_add_u32 s50, s50, 8192
    s_min_u32 s43, s50, 160768
    s_mov_b32 m0, s43
    s_add_u32 s43, s43, 3145728
    buffer_load_dwordx4 v3, s[28:31], s43 offen lds
    s_add_u32 s50, s50, 8192
    s_min_u32 s43, s50, 160768
    s_mov_b32 m0, s43
    s_add_u32 s43, s43, 3145728
    buffer_load_dwordx4 v3, s[28:31], s43 offen lds
    s_add_u32 s50, s50, 8192
    s_min_u32 s43, s50, 160768
    s_mov_b32 m0, s43
    s_add_u32 s43, s43, 3145728
    buffer_load_dwordx4 v3, s[28:31], s43 offen lds
    s_add_u32 s50, s50, 8192
L_attn0_kernel_sk5:
    s_waitcnt lgkmcnt(0)
    v_mfma_f32_32x32x16_bf16 v[32:47], v[96:99], v[8:11], v[16:31]
    ds_read_b128 v[104:107], v128 offset:18816
    ds_read_b32 v108, v129 offset:18816
    v_exp_f32 v48, v48
    v_exp_f32 v49, v49
    v_exp_f32 v50, v50
    v_exp_f32 v51, v51
    v_mfma_f32_32x32x16_bf16 v[64:79], v[112:115], v[80:83], v[64:79]
    ds_read_b128 v[120:123], v130 offset:13440
    ds_read_b128 v[124:127], v130 offset:14144
    v_exp_f32 v52, v52
    v_exp_f32 v53, v53
    v_exp_f32 v54, v54
    v_exp_f32 v55, v55
    v_cvt_pk_bf16_f32 v88, v48, v49
    v_cvt_pk_bf16_f32 v89, v50, v51
    v_cvt_pk_bf16_f32 v90, v52, v53
    v_cvt_pk_bf16_f32 v91, v54, v55
    v_mfma_f32_32x32x16_bf16 v[32:47], v[100:103], v[12:15], v[32:47]
    v_exp_f32 v56, v56
    v_exp_f32 v57, v57
    v_exp_f32 v58, v58
    v_exp_f32 v59, v59
    v_mfma_f32_32x32x16_bf16 v[64:79], v[116:119], v[84:87], v[64:79]
    v_exp_f32 v60, v60
    v_exp_f32 v61, v61
    v_exp_f32 v62, v62
    v_exp_f32 v63, v63
    v_cvt_pk_bf16_f32 v92, v56, v57
    v_cvt_pk_bf16_f32 v93, v58, v59
    v_cvt_pk_bf16_f32 v94, v60, v61
    v_cvt_pk_bf16_f32 v95, v62, v63
    s_waitcnt lgkmcnt(0)
    v_mfma_f32_32x32x16_bf16 v[48:63], v[104:107], v[8:11], v[16:31]
    ds_read_b128 v[96:99], v128 offset:21504
    ds_read_b32 v100, v129 offset:21504
    v_exp_f32 v32, v32
    v_exp_f32 v33, v33
    v_exp_f32 v34, v34
    v_exp_f32 v35, v35
    v_mfma_f32_32x32x16_bf16 v[64:79], v[120:123], v[88:91], v[64:79]
    ds_read_b128 v[112:115], v130 offset:16128
    ds_read_b128 v[116:119], v130 offset:16832
    v_exp_f32 v36, v36
    v_exp_f32 v37, v37
    v_exp_f32 v38, v38
    v_exp_f32 v39, v39
    v_cvt_pk_bf16_f32 v80, v32, v33
    v_cvt_pk_bf16_f32 v81, v34, v35
    v_cvt_pk_bf16_f32 v82, v36, v37
    v_cvt_pk_bf16_f32 v83, v38, v39
    v_mfma_f32_32x32x16_bf16 v[48:63], v[108:111], v[12:15], v[48:63]
    v_exp_f32 v40, v40
    v_exp_f32 v41, v41
    v_exp_f32 v42, v42
    v_exp_f32 v43, v43
    v_mfma_f32_32x32x16_bf16 v[64:79], v[124:127], v[92:95], v[64:79]
    v_exp_f32 v44, v44
    v_exp_f32 v45, v45
    v_exp_f32 v46, v46
    v_exp_f32 v47, v47
    v_cvt_pk_bf16_f32 v84, v40, v41
    v_cvt_pk_bf16_f32 v85, v42, v43
    v_cvt_pk_bf16_f32 v86, v44, v45
    v_cvt_pk_bf16_f32 v87, v46, v47
    s_waitcnt lgkmcnt(0)
    v_mfma_f32_32x32x16_bf16 v[32:47], v[96:99], v[8:11], v[16:31]
    ds_read_b128 v[104:107], v128 offset:24192
    ds_read_b32 v108, v129 offset:24192
    v_exp_f32 v48, v48
    v_exp_f32 v49, v49
    v_exp_f32 v50, v50
    v_exp_f32 v51, v51
    v_mfma_f32_32x32x16_bf16 v[64:79], v[112:115], v[80:83], v[64:79]
    ds_read_b128 v[120:123], v130 offset:18816
    ds_read_b128 v[124:127], v130 offset:19520
    v_exp_f32 v52, v52
    v_exp_f32 v53, v53
    v_exp_f32 v54, v54
    v_exp_f32 v55, v55
    v_cvt_pk_bf16_f32 v88, v48, v49
    v_cvt_pk_bf16_f32 v89, v50, v51
    v_cvt_pk_bf16_f32 v90, v52, v53
    v_cvt_pk_bf16_f32 v91, v54, v55
    v_mfma_f32_32x32x16_bf16 v[32:47], v[100:103], v[12:15], v[32:47]
    v_exp_f32 v56, v56
    v_exp_f32 v57, v57
    v_exp_f32 v58, v58
    v_exp_f32 v59, v59
    v_mfma_f32_32x32x16_bf16 v[64:79], v[116:119], v[84:87], v[64:79]
    v_exp_f32 v60, v60
    v_exp_f32 v61, v61
    v_exp_f32 v62, v62
    v_exp_f32 v63, v63
    v_cvt_pk_bf16_f32 v92, v56, v57
    v_cvt_pk_bf16_f32 v93, v58, v59
    v_cvt_pk_bf16_f32 v94, v60, v61
    v_cvt_pk_bf16_f32 v95, v62, v63
    s_cmp_lg_u32 s41, 0
    s_cbranch_scc1 L_attn0_kernel_sk8
    s_min_u32 s43, s50, 160768
    s_mov_b32 m0, s43
    s_add_u32 s43, s43, 3145728
    buffer_load_dwordx4 v3, s[28:31], s43 offen lds
    s_add_u32 s50, s50, 8192
    s_min_u32 s43, s50, 160768
    s_mov_b32 m0, s43
    s_add_u32 s43, s43, 3145728
    buffer_load_dwordx4 v3, s[28:31], s43 offen lds
    s_add_u32 s50, s50, 8192
    s_min_u32 s43, s50, 160768
    s_mov_b32 m0, s43
    s_add_u32 s43, s43, 3145728
    buffer_load_dwordx4 v3, s[28:31], s43 offen lds
    s_add_u32 s50, s50, 8192
    s_min_u32 s43, s50, 160768
    s_mov_b32 m0, s43
    s_add_u32 s43, s43, 3145728
    buffer_load_dwordx4 v3, s[28:31], s43 offen lds
    s_add_u32 s50, s50, 8192
L_attn0_kernel_sk8:
    s_waitcnt lgkmcnt(0)
    v_mfma_f32_32x32x16_bf16 v[48:63], v[104:107], v[8:11], v[16:31]
    ds_read_b128 v[96:99], v128 offset:26880
    ds_read_b32 v100, v129 offset:26880
    v_exp_f32 v32, v32
    v_exp_f32 v33, v33
    v_exp_f32 v34, v34
    v_exp_f32 v35, v35
    v_mfma_f32_32x32x16_bf16 v[64:79], v[120:123], v[88:91], v[64:79]
    ds_read_b128 v[112:115], v130 offset:21504
    ds_read_b128 v[116:119], v130 offset:22208
    v_exp_f32 v36, v36
    v_exp_f32 v37, v37
    v_exp_f32 v38, v38
    v_exp_f32 v39, v39
    v_cvt_pk_bf16_f32 v80, v32, v33
    v_cvt_pk_bf16_f32 v81, v34, v35
    v_cvt_pk_bf16_f32 v82, v36, v37
    v_cvt_pk_bf16_f32 v83, v38, v39
    v_mfma_f32_32x32x16_bf16 v[48:63], v[108:111], v[12:15], v[48:63]
    v_exp_f32 v40, v40
    v_exp_f32 v41, v41
    v_exp_f32 v42, v42
    v_exp_f32 v43, v43
    v_mfma_f32_32x32x16_bf16 v[64:79], v[124:127], v[92:95], v[64:79]
    v_exp_f32 v44, v44
    v_exp_f32 v45, v45
    v_exp_f32 v46, v46
    v_exp_f32 v47, v47
    v_cvt_pk_bf16_f32 v84, v40, v41
    v_cvt_pk_bf16_f32 v85, v42, v43
    v_cvt_pk_bf16_f32 v86, v44, v45
    v_cvt_pk_bf16_f32 v87, v46, v47
    s_cmp_lg_u32 s41, 1
    s_cbranch_scc1 L_attn0_kernel_pf9
    buffer_load_dwordx4 v[140:143], v3, s[20:23], s55 offen offset:0
    buffer_load_dwordx4 v[140:143], v3, s[20:23], s55 offen offset:1024
    buffer_load_dwordx4 v[140:143], v3, s[20:23], s55 offen offset:2048
    buffer_load_dwordx4 v[140:143], v3, s[20:23], s55 offen offset:2176
    buffer_load_dwordx4 v[140:143], v136, s[24:27], s56 offen offset:0
    buffer_load_dwordx4 v[140:143], v136, s[24:27], s56 offen offset:128
    buffer_load_dwordx4 v[140:143], v136, s[24:27], s56 offen offset:256
    buffer_load_dwordx4 v[140:143], v136, s[24:27], s56 offen offset:384
    buffer_load_dwordx4 v[140:143], v136, s[24:27], s56 offen offset:512
    s_getpc_b64 s[90:91]
L_pc_ref2:
    s_sub_u32 s90, s90, L_pc_ref2 - L_text_start
    s_subb_u32 s91, s91, 0
    s_lshr_b32 s92, s2, 3
    s_mul_i32 s92, s92, 8
    s_add_u32 s92, s92, s32
    s_lshl_b32 s92, s92, 9
    s_min_u32 s92, s92, L_text_end - L_text_start - 512
    s_add_u32 s90, s90, s92
    s_addc_u32 s91, s91, 0
    v_lshlrev_b32 v137, 3, v0
    global_load_dwordx2 v[140:141], v137, s[90:91]
L_attn0_kernel_pf9:
    s_waitcnt lgkmcnt(0)
    v_mfma_f32_32x32x16_bf16 v[32:47], v[96:99], v[8:11], v[16:31]
    ds_read_b128 v[104:107], v128 offset:29568
    ds_read_b32 v108, v129 offset:29568
    v_exp_f32 v48, v48
    v_exp_f32 v49, v49
    v_exp_f32 v50, v50
    v_exp_f32 v51, v51
    v_mfma_f32_32x32x16_bf16 v[64:79], v[112:115], v[80:83], v[64:79]
    ds_read_b128 v[120:123], v130 offset:24192
    ds_read_b128 v[124:127], v130 offset:24896
    v_exp_f32 v52, v52
    v_exp_f32 v53, v53
    v_exp_f32 v54, v54
    v_exp_f32 v55, v55
    v_cvt_pk_bf16_f32 v88, v48, v49
    v_cvt_pk_bf16_f32 v89, v50, v51
    v_cvt_pk_bf16_f32 v90, v52, v53
    v_cvt_pk_bf16_f32 v91, v54, v55
    v_mfma_f32_32x32x16_bf16 v[32:47], v[100:103], v[12:15], v[32:47]
    v_exp_f32 v56, v56
    v_exp_f32 v57, v57
    v_exp_f32 v58, v58
    v_exp_f32 v59, v59
    v_mfma_f32_32x32x16_bf16 v[64:79], v[116:119], v[84:87], v[64:79]
    v_exp_f32 v60, v60
    v_exp_f32 v61, v61
    v_exp_f32 v62, v62
    v_exp_f32 v63, v63
    v_cvt_pk_bf16_f32 v92, v56, v57
    v_cvt_pk_bf16_f32 v93, v58, v59
    v_cvt_pk_bf16_f32 v94, v60, v61
    v_cvt_pk_bf16_f32 v95, v62, v63
    s_waitcnt lgkmcnt(0)
    v_mfma_f32_32x32x16_bf16 v[48:63], v[104:107], v[8:11], v[16:31]
    ds_read_b128 v[96:99], v128 offset:32256
    ds_read_b32 v100, v129 offset:32256
    v_exp_f32 v32, v32
    v_exp_f32 v33, v33
    v_exp_f32 v34, v34
    v_exp_f32 v35, v35
    v_mfma_f32_32x32x16_bf16 v[64:79], v[120:123], v[88:91], v[64:79]
    ds_read_b128 v[112:115], v130 offset:26880
    ds_read_b128 v[116:119], v130 offset:27584
    v_exp_f32 v36, v36
    v_exp_f32 v37, v37
    v_exp_f32 v38, v38
    v_exp_f32 v39, v39
    v_cvt_pk_bf16_f32 v80, v32, v33
    v_cvt_pk_bf16_f32 v81, v34, v35
    v_cvt_pk_bf16_f32 v82, v36, v37
    v_cvt_pk_bf16_f32 v83, v38, v39
    v_mfma_f32_32x32x16_bf16 v[48:63], v[108:111], v[12:15], v[48:63]
    v_exp_f32 v40, v40
    v_exp_f32 v41, v41
    v_exp_f32 v42, v42
    v_exp_f32 v43, v43
    v_mfma_f32_32x32x16_bf16 v[64:79], v[124:127], v[92:95], v[64:79]
    v_exp_f32 v44, v44
    v_exp_f32 v45, v45
    v_exp_f32 v46, v46
    v_exp_f32 v47, v47
    v_cvt_pk_bf16_f32 v84, v40, v41
    v_cvt_pk_bf16_f32 v85, v42, v43
    v_cvt_pk_bf16_f32 v86, v44, v45
    v_cvt_pk_bf16_f32 v87, v46, v47
    s_cmp_lg_u32 s41, 0
    s_cbranch_scc1 L_attn0_kernel_sk11
    s_min_u32 s43, s50, 160768
    s_mov_b32 m0, s43
    s_add_u32 s43, s43, 3145728
    buffer_load_dwordx4 v3, s[28:31], s43 offen lds
    s_add_u32 s50, s50, 8192
    s_min_u32 s43, s50, 160768
    s_mov_b32 m0, s43
    s_add_u32 s43, s43, 3145728
    buffer_load_dwordx4 v3, s[28:31], s43 offen lds
    s_add_u32 s50, s50, 8192
L_attn0_kernel_sk11:
    s_waitcnt lgkmcnt(0)
    v_mfma_f32_32x32x16_bf16 v[32:47], v[96:99], v[8:11], v[16:31]
    ds_read_b128 v[104:107], v128 offset:34944
    ds_read_b32 v108, v129 offset:34944
    v_exp_f32 v48, v48
    v_exp_f32 v49, v49
    v_exp_f32 v50, v50
    v_exp_f32 v51, v51
    v_mfma_f32_32x32x16_bf16 v[64:79], v[112:115], v[80:83], v[64:79]
    ds_read_b128 v[120:123], v130 offset:29568
    ds_read_b128 v[124:127], v130 offset:30272
    v_exp_f32 v52, v52
    v_exp_f32 v53, v53
    v_exp_f32 v54, v54
    v_exp_f32 v55, v55
    v_cvt_pk_bf16_f32 v88, v48, v49
    v_cvt_pk_bf16_f32 v89, v50, v51
    v_cvt_pk_bf16_f32 v90, v52, v53
    v_cvt_pk_bf16_f32 v91, v54, v55
    v_mfma_f32_32x32x16_bf16 v[32:47], v[100:103], v[12:15], v[32:47]
    v_exp_f32 v56, v56
    v_exp_f32 v57, v57
    v_exp_f32 v58, v58
    v_exp_f32 v59, v59
    v_mfma_f32_32x32x16_bf16 v[64:79], v[116:119], v[84:87], v[64:79]
    v_exp_f32 v60, v60
    v_exp_f32 v61, v61
    v_exp_f32 v62, v62
    v_exp_f32 v63, v63
    v_cvt_pk_bf16_f32 v92, v56, v57
    v_cvt_pk_bf16_f32 v93, v58, v59
    v_cvt_pk_bf16_f32 v94, v60, v61
    v_cvt_pk_bf16_f32 v95, v62, v63
    s_setprio 0
    s_waitcnt lgkmcnt(0)
    v_mfma_f32_32x32x16_bf16 v[48:63], v[104:107], v[8:11], v[16:31]
    ds_read_b128 v[96:99], v128 offset:37632
    ds_read_b32 v100, v129 offset:37632
    v_exp_f32 v32, v32
    v_exp_f32 v33, v33
    v_exp_f32 v34, v34
    v_exp_f32 v35, v35
    v_mfma_f32_32x32x16_bf16 v[64:79], v[120:123], v[88:91], v[64:79]
    ds_read_b128 v[112:115], v130 offset:32256
    ds_read_b128 v[116:119], v130 offset:32960
    v_exp_f32 v36, v36
    v_exp_f32 v37, v37
    v_exp_f32 v38, v38
    v_exp_f32 v39, v39
    v_cvt_pk_bf16_f32 v80, v32, v33
    v_cvt_pk_bf16_f32 v81, v34, v35
    v_cvt_pk_bf16_f32 v82, v36, v37
    v_cvt_pk_bf16_f32 v83, v38, v39
    v_mfma_f32_32x32x16_bf16 v[48:63], v[108:111], v[12:15], v[48:63]
    v_exp_f32 v40, v40
    v_exp_f32 v41, v41
    v_exp_f32 v42, v42
    v_exp_f32 v43, v43
    v_mfma_f32_32x32x16_bf16 v[64:79], v[124:127], v[92:95], v[64:79]
    v_exp_f32 v44, v44
    v_exp_f32 v45, v45
    v_exp_f32 v46, v46
    v_exp_f32 v47, v47
    v_cvt_pk_bf16_f32 v84, v40, v41
    v_cvt_pk_bf16_f32 v85, v42, v43
    v_cvt_pk_bf16_f32 v86, v44, v45
    v_cvt_pk_bf16_f32 v87, v46, v47
    s_waitcnt lgkmcnt(0)
    v_mfma_f32_32x32x16_bf16 v[32:47], v[96:99], v[8:11], v[16:31]
    ds_read_b128 v[104:107], v128 offset:40320
    ds_read_b32 v108, v129 offset:40320
    v_exp_f32 v48, v48
    v_exp_f32 v49, v49
    v_exp_f32 v50, v50
    v_exp_f32 v51, v51
    v_mfma_f32_32x32x16_bf16 v[64:79], v[112:115], v[80:83], v[64:79]
    ds_read_b128 v[120:123], v130 offset:34944
    ds_read_b128 v[124:127], v130 offset:35648
    v_exp_f32 v52, v52
    v_exp_f32 v53, v53
    v_exp_f32 v54, v54
    v_exp_f32 v55, v55
    v_cvt_pk_bf16_f32 v88, v48, v49
    v_cvt_pk_bf16_f32 v89, v50, v51
    v_cvt_pk_bf16_f32 v90, v52, v53
    v_cvt_pk_bf16_f32 v91, v54, v55
    v_mfma_f32_32x32x16_bf16 v[32:47], v[100:103], v[12:15], v[32:47]
    v_exp_f32 v56, v56
    v_exp_f32 v57, v57
    v_exp_f32 v58, v58
    v_exp_f32 v59, v59
    v_mfma_f32_32x32x16_bf16 v[64:79], v[116:119], v[84:87], v[64:79]
    v_exp_f32 v60, v60
    v_exp_f32 v61, v61
    v_exp_f32 v62, v62
    v_exp_f32 v63, v63
    v_cvt_pk_bf16_f32 v92, v56, v57
    v_cvt_pk_bf16_f32 v93, v58, v59
    v_cvt_pk_bf16_f32 v94, v60, v61
    v_cvt_pk_bf16_f32 v95, v62, v63
    s_cmp_lg_u32 s41, 0
    s_cbranch_scc1 L_attn0_kernel_nb14
    s_waitcnt vmcnt(0)
    s_barrier
L_attn0_kernel_nb14:
    s_waitcnt lgkmcnt(0)
    v_mfma_f32_32x32x16_bf16 v[48:63], v[104:107], v[8:11], v[16:31]
    ds_read_b128 v[96:99], v128 offset:43008
    ds_read_b32 v100, v129 offset:43008
    v_exp_f32 v32, v32
    v_exp_f32 v33, v33
    v_exp_f32 v34, v34
    v_exp_f32 v35, v35
    v_mfma_f32_32x32x16_bf16 v[64:79], v[120:123], v[88:91], v[64:79]
    ds_read_b128 v[112:115], v130 offset:37632
    ds_read_b128 v[116:119], v130 offset:38336
    v_exp_f32 v36, v36
    v_exp_f32 v37, v37
    v_exp_f32 v38, v38
    v_exp_f32 v39, v39
    v_cvt_pk_bf16_f32 v80, v32, v33
    v_cvt_pk_bf16_f32 v81, v34, v35
    v_cvt_pk_bf16_f32 v82, v36, v37
    v_cvt_pk_bf16_f32 v83, v38, v39
    v_mfma_f32_32x32x16_bf16 v[48:63], v[108:111], v[12:15], v[48:63]
    v_exp_f32 v40, v40
    v_exp_f32 v41, v41
    v_exp_f32 v42, v42
    v_exp_f32 v43, v43
    v_mfma_f32_32x32x16_bf16 v[64:79], v[124:127], v[92:95], v[64:79]
    v_exp_f32 v44, v44
    v_exp_f32 v45, v45
    v_exp_f32 v46, v46
    v_exp_f32 v47, v47
    v_cvt_pk_bf16_f32 v84, v40, v41
    v_cvt_pk_bf16_f32 v85, v42, v43
    v_cvt_pk_bf16_f32 v86, v44, v45
    v_cvt_pk_bf16_f32 v87, v46, v47
    s_waitcnt lgkmcnt(0)
    v_mfma_f32_32x32x16_bf16 v[32:47], v[96:99], v[8:11], v[16:31]
    ds_read_b128 v[104:107], v128 offset:45696
    ds_read_b32 v108, v129 offset:45696
    v_exp_f32 v48, v48
    v_exp_f32 v49, v49
    v_exp_f32 v50, v50
    v_exp_f32 v51, v51
    v_mfma_f32_32x32x16_bf16 v[64:79], v[112:115], v[80:83], v[64:79]
    ds_read_b128 v[120:123], v130 offset:40320
    ds_read_b128 v[124:127], v130 offset:41024
    v_exp_f32 v52, v52
    v_exp_f32 v53, v53
    v_exp_f32 v54, v54
    v_exp_f32 v55, v55
    v_cvt_pk_bf16_f32 v88, v48, v49
    v_cvt_pk_bf16_f32 v89, v50, v51
    v_cvt_pk_bf16_f32 v90, v52, v53
    v_cvt_pk_bf16_f32 v91, v54, v55
    v_mfma_f32_32x32x16_bf16 v[32:47], v[100:103], v[12:15], v[32:47]
    v_exp_f32 v56, v56
    v_exp_f32 v57, v57
    v_exp_f32 v58, v58
    v_exp_f32 v59, v59
    v_mfma_f32_32x32x16_bf16 v[64:79], v[116:119], v[84:87], v[64:79]
    v_exp_f32 v60, v60
    v_exp_f32 v61, v61
    v_exp_f32 v62, v62
    v_exp_f32 v63, v63
    v_cvt_pk_bf16_f32 v92, v56, v57
    v_cvt_pk_bf16_f32 v93, v58, v59
    v_cvt_pk_bf16_f32 v94, v60, v61
    v_cvt_pk_bf16_f32 v95, v62, v63
    v_add_u32 v128, 43008, v128
    v_add_u32 v129, 43008, v129
    v_add_u32 v130, 43008, v130
    s_add_u32 s41, s41, 1
    s_add_u32 s42, s42, 1
    s_cmp_lt_u32 s42, 3
    s_cbranch_scc1 L_attn0_kernel_chunk
    s_load_dwordx2 s[4:5], s[0:1], 0
    s_lshr_b32 s58, s33, 6
    s_lshr_b32 s59, s2, 5
    s_mul_i32 s36, s59, 160
    s_mov_b32 s37, 6554
    s_movk_i32 s38, 1280
    v_add_u32 v4, 0, v0
    v_mul_lo_u32 v5, v4, s37
    v_lshrrev_b32 v5, 16, v5
    v_mul_u32_u24 v6, 10, v5
    v_sub_u32 v6, v4, v6
    v_mul_lo_u32 v5, v5, s38
    v_lshl_add_u32 v5, v6, 4, v5
    v_add_u32 v5, s36, v5
    v_subrev_u32 v208, 0, v5
    v_add_u32 v4, 64, v0
    v_mul_lo_u32 v5, v4, s37
    v_lshrrev_b32 v5, 16, v5
    v_mul_u32_u24 v6, 10, v5
    v_sub_u32 v6, v4, v6
    v_mul_lo_u32 v5, v5, s38
    v_lshl_add_u32 v5, v6, 4, v5
    v_add_u32 v5, s36, v5
    v_subrev_u32 v209, 1024, v5
    v_add_u32 v4, 128, v0
    v_mul_lo_u32 v5, v4, s37
    v_lshrrev_b32 v5, 16, v5
    v_mul_u32_u24 v6, 10, v5
    v_sub_u32 v6, v4, v6
    v_mul_lo_u32 v5, v5, s38
    v_lshl_add_u32 v5, v6, 4, v5
    v_add_u32 v5, s36, v5
    v_subrev_u32 v210, 2048, v5
    v_add_u32 v4, 192, v0
    v_mul_lo_u32 v5, v4, s37
    v_lshrrev_b32 v5, 16, v5
    v_mul_u32_u24 v6, 10, v5
    v_sub_u32 v6, v4, v6
    v_mul_lo_u32 v5, v5, s38
    v_lshl_add_u32 v5, v6, 4, v5
    v_add_u32 v5, s36, v5
    v_subrev_u32 v211, 3072, v5
    v_add_u32 v4, 256, v0
    v_mul_lo_u32 v5, v4, s37
    v_lshrrev_b32 v5, 16, v5
    v_mul_u32_u24 v6, 10, v5
    v_sub_u32 v6, v4, v6
    v_mul_lo_u32 v5, v5, s38
    v_lshl_add_u32 v5, v6, 4, v5
    v_add_u32 v5, s36, v5
    v_subrev_u32 v212, 0, v5
    s_waitcnt vmcnt(0) lgkmcnt(0)
    s_add_u32 s8, s12, 0xe00000
    s_addc_u32 s9, s13, 0
    s_cmp_eq_u32 s99, 0
    s_cselect_b32 s4, s4, s8
    s_cselect_b32 s5, s5, s9
    s_mov_b32 s16, s4
    s_and_b32 s17, s5, 0xffff
    s_mov_b32 s18, 0x280000
    s_mov_b32 s19, 0x00020000
    s_mul_i32 s60, s32, 40960
    s_mul_i32 s61, s32, 5120
    s_barrier
    s_cmp_lt_u32 s32, 4
    s_cbranch_scc1 L_attn0_kernel_npL
    s_setprio 1
L_attn0_kernel_npL:
    s_waitcnt lgkmcnt(0)
    v_mfma_f32_32x32x16_bf16 v[48:63], v[104:107], v[8:11], v[16:31]
    ds_read_b128 v[96:99], v128 offset:5376
    ds_read_b32 v100, v129 offset:5376
    v_exp_f32 v32, v32
    v_exp_f32 v33, v33
    v_exp_f32 v34, v34
    v_exp_f32 v35, v35
    v_mfma_f32_32x32x16_bf16 v[64:79], v[120:123], v[88:91], v[64:79]
    ds_read_b128 v[112:115], v130 offset:0
    ds_read_b128 v[116:119], v130 offset:704
    v_exp_f32 v36, v36
    v_exp_f32 v37, v37
    v_exp_f32 v38, v38
    v_exp_f32 v39, v39
    v_cvt_pk_bf16_f32 v80, v32, v33
    v_cvt_pk_bf16_f32 v81, v34, v35
    v_cvt_pk_bf16_f32 v82, v36, v37
    v_cvt_pk_bf16_f32 v83, v38, v39
    v_mfma_f32_32x32x16_bf16 v[48:63], v[108:111], v[12:15], v[48:63]
    v_exp_f32 v40, v40
    v_exp_f32 v41, v41
    v_exp_f32 v42, v42
    v_exp_f32 v43, v43
    v_mfma_f32_32x32x16_bf16 v[64:79], v[124:127], v[92:95], v[64:79]
    v_exp_f32 v44, v44
    v_exp_f32 v45, v45
    v_exp_f32 v46, v46
    v_exp_f32 v47, v47
    v_cvt_pk_bf16_f32 v84, v40, v41
    v_cvt_pk_bf16_f32 v85, v42, v43
    v_cvt_pk_bf16_f32 v86, v44, v45
    v_cvt_pk_bf16_f32 v87, v46, v47
    s_mov_b32 m0, s61
    s_add_u32 s45, s61, 4096
    buffer_load_dwordx4 v208, s[20:23], s60 offen offset:0 lds
    buffer_load_dwordx4 v209, s[20:23], s60 offen offset:1024 lds
    buffer_load_dwordx4 v210, s[20:23], s60 offen offset:2048 lds
    buffer_load_dwordx4 v211, s[20:23], s60 offen offset:3072 lds
    s_mov_b32 m0, s45
    s_nop 0
    buffer_load_dwordx4 v212, s[20:23], s60 offen lds
    s_add_u32 s60, s60, 327680
    s_add_u32 s61, s61, 40960
    s_waitcnt lgkmcnt(0)
    v_mfma_f32_32x32x16_bf16 v[32:47], v[96:99], v[8:11], v[16:31]
    ds_read_b128 v[104:107], v128 offset:8064
    ds_read_b32 v108, v129 offset:8064
    v_exp_f32 v48, v48
    v_exp_f32 v49, v49
    v_exp_f32 v50, v50
    v_exp_f32 v51, v51
    v_mfma_f32_32x32x16_bf16 v[64:79], v[112:115], v[80:83], v[64:79]
    ds_read_b128 v[120:123], v130 offset:2688
    ds_read_b128 v[124:127], v130 offset:3392
    v_exp_f32 v52, v52
    v_exp_f32 v53, v53
    v_exp_f32 v54, v54
    v_exp_f32 v55, v55
    v_cvt_pk_bf16_f32 v88, v48, v49
    v_cvt_pk_bf16_f32 v89, v50, v51
    v_cvt_pk_bf16_f32 v90, v52, v53
    v_cvt_pk_bf16_f32 v91, v54, v55
    v_mfma_f32_32x32x16_bf16 v[32:47], v[100:103], v[12:15], v[32:47]
    v_exp_f32 v56, v56
    v_exp_f32 v57, v57
    v_exp_f32 v58, v58
    v_exp_f32 v59, v59
    v_mfma_f32_32x32x16_bf16 v[64:79], v[116:119], v[84:87], v[64:79]
    v_exp_f32 v60, v60
    v_exp_f32 v61, v61
    v_exp_f32 v62, v62
    v_exp_f32 v63, v63
    v_cvt_pk_bf16_f32 v92, v56, v57
    v_cvt_pk_bf16_f32 v93, v58, v59
    v_cvt_pk_bf16_f32 v94, v60, v61
    v_cvt_pk_bf16_f32 v95, v62, v63
    s_waitcnt lgkmcnt(0)
    v_mfma_f32_32x32x16_bf16 v[48:63], v[104:107], v[8:11], v[16:31]
    ds_read_b128 v[96:99], v128 offset:10752
    ds_read_b32 v100, v129 offset:10752
    v_exp_f32 v32, v32
    v_exp_f32 v33, v33
    v_exp_f32 v34, v34
    v_exp_f32 v35, v35
    v_mfma_f32_32x32x16_bf16 v[64:79], v[120:123], v[88:91], v[64:79]
    ds_read_b128 v[112:115], v130 offset:5376
    ds_read_b128 v[116:119], v130 offset:6080
    v_exp_f32 v36, v36
    v_exp_f32 v37, v37
    v_exp_f32 v38, v38
    v_exp_f32 v39, v39
    v_cvt_pk_bf16_f32 v80, v32, v33
    v_cvt_pk_bf16_f32 v81, v34, v35
    v_cvt_pk_bf16_f32 v82, v36, v37
    v_cvt_pk_bf16_f32 v83, v38, v39
    v_mfma_f32_32x32x16_bf16 v[48:63], v[108:111], v[12:15], v[48:63]
    v_exp_f32 v40, v40
    v_exp_f32 v41, v41
    v_exp_f32 v42, v42
    v_exp_f32 v43, v43
    v_mfma_f32_32x32x16_bf16 v[64:79], v[124:127], v[92:95], v[64:79]
    v_exp_f32 v44, v44
    v_exp_f32 v45, v45
    v_exp_f32 v46, v46
    v_exp_f32 v47, v47
    v_cvt_pk_bf16_f32 v84, v40, v41
    v_cvt_pk_bf16_f32 v85, v42, v43
    v_cvt_pk_bf16_f32 v86, v44, v45
    v_cvt_pk_bf16_f32 v87, v46, v47
    s_waitcnt lgkmcnt(0)
    v_mfma_f32_32x32x16_bf16 v[32:47], v[96:99], v[8:11], v[16:31]
    ds_read_b128 v[104:107], v128 offset:13440
    ds_read_b32 v108, v129 offset:13440
    v_exp_f32 v48, v48
    v_exp_f32 v49, v49
    v_exp_f32 v50, v50
    v_exp_f32 v51, v51
    v_mfma_f32_32x32x16_bf16 v[64:79], v[112:115], v[80:83], v[64:79]
    ds_read_b128 v[120:123], v130 offset:8064
    ds_read_b128 v[124:127], v130 offset:8768
    v_exp_f32 v52, v52
    v_exp_f32 v53, v53
    v_exp_f32 v54, v54
    v_exp_f32 v55, v55
    v_cvt_pk_bf16_f32 v88, v48, v49
    v_cvt_pk_bf16_f32 v89, v50, v51
    v_cvt_pk_bf16_f32 v90, v52, v53
    v_cvt_pk_bf16_f32 v91, v54, v55
    v_mfma_f32_32x32x16_bf16 v[32:47], v[100:103], v[12:15], v[32:47]
    v_exp_f32 v56, v56
    v_exp_f32 v57, v57
    v_exp_f32 v58, v58
    v_exp_f32 v59, v59
    v_mfma_f32_32x32x16_bf16 v[64:79], v[116:119], v[84:87], v[64:79]
    v_exp_f32 v60, v60
    v_exp_f32 v61, v61
    v_exp_f32 v62, v62
    v_exp_f32 v63, v63
    v_cvt_pk_bf16_f32 v92, v56, v57
    v_cvt_pk_bf16_f32 v93, v58, v59
    v_cvt_pk_bf16_f32 v94, v60, v61
    v_cvt_pk_bf16_f32 v95, v62, v63
    s_waitcnt lgkmcnt(0)
    v_mfma_f32_32x32x16_bf16 v[48:63], v[104:107], v[8:11], v[16:31]
    ds_read_b128 v[96:99], v128 offset:16128
    ds_read_b32 v100, v129 offset:16128
    v_exp_f32 v32, v32
    v_exp_f32 v33, v33
    v_exp_f32 v34, v34
    v_exp_f32 v35, v35
    v_mfma_f32_32x32x16_bf16 v[64:79], v[120:123], v[88:91], v[64:79]
    ds_read_b128 v[112:115], v130 offset:10752
    ds_read_b128 v[116:119], v130 offset:11456
    v_exp_f32 v36, v36
    v_exp_f32 v37, v37
    v_exp_f32 v38, v38
    v_exp_f32 v39, v39
    v_cvt_pk_bf16_f32 v80, v32, v33
    v_cvt_pk_bf16_f32 v81, v34, v35
    v_cvt_pk_bf16_f32 v82, v36, v37
    v_cvt_pk_bf16_f32 v83, v38, v39
    v_mfma_f32_32x32x16_bf16 v[48:63], v[108:111], v[12:15], v[48:63]
    v_exp_f32 v40, v40
    v_exp_f32 v41, v41
    v_exp_f32 v42, v42
    v_exp_f32 v43, v43
    v_mfma_f32_32x32x16_bf16 v[64:79], v[124:127], v[92:95], v[64:79]
    v_exp_f32 v44, v44
    v_exp_f32 v45, v45
    v_exp_f32 v46, v46
    v_exp_f32 v47, v47
    v_cvt_pk_bf16_f32 v84, v40, v41
    v_cvt_pk_bf16_f32 v85, v42, v43
    v_cvt_pk_bf16_f32 v86, v44, v45
    v_cvt_pk_bf16_f32 v87, v46, v47
    s_mov_b32 m0, s61
    s_add_u32 s45, s61, 4096
    buffer_load_dwordx4 v208, s[20:23], s60 offen offset:0 lds
    buffer_load_dwordx4 v209, s[20:23], s60 offen offset:1024 lds
    buffer_load_dwordx4 v210, s[20:23], s60 offen offset:2048 lds
    buffer_load_dwordx4 v211, s[20:23], s60 offen offset:3072 lds
    s_mov_b32 m0, s45
    s_nop 0
    buffer_load_dwordx4 v212, s[20:23], s60 offen lds
    s_add_u32 s60, s60, 327680
    s_add_u32 s61, s61, 40960
    s_waitcnt lgkmcnt(0)
    v_mfma_f32_32x32x16_bf16 v[32:47], v[96:99], v[8:11], v[16:31]
    ds_read_b128 v[104:107], v128 offset:18816
    ds_read_b32 v108, v129 offset:18816
    v_exp_f32 v48, v48
    v_exp_f32 v49, v49
    v_exp_f32 v50, v50
    v_exp_f32 v51, v51
    v_mfma_f32_32x32x16_bf16 v[64:79], v[112:115], v[80:83], v[64:79]
    ds_read_b128 v[120:123], v130 offset:13440
    ds_read_b128 v[124:127], v130 offset:14144
    v_exp_f32 v52, v52
    v_exp_f32 v53, v53
    v_exp_f32 v54, v54
    v_exp_f32 v55, v55
    v_cvt_pk_bf16_f32 v88, v48, v49
    v_cvt_pk_bf16_f32 v89, v50, v51
    v_cvt_pk_bf16_f32 v90, v52, v53
    v_cvt_pk_bf16_f32 v91, v54, v55
    v_mfma_f32_32x32x16_bf16 v[32:47], v[100:103], v[12:15], v[32:47]
    v_exp_f32 v56, v56
    v_exp_f32 v57, v57
    v_exp_f32 v58, v58
    v_exp_f32 v59, v59
    v_mfma_f32_32x32x16_bf16 v[64:79], v[116:119], v[84:87], v[64:79]
    v_exp_f32 v60, v60
    v_exp_f32 v61, v61
    v_exp_f32 v62, v62
    v_exp_f32 v63, v63
    v_cvt_pk_bf16_f32 v92, v56, v57
    v_cvt_pk_bf16_f32 v93, v58, v59
    v_cvt_pk_bf16_f32 v94, v60, v61
    v_cvt_pk_bf16_f32 v95, v62, v63
    s_waitcnt lgkmcnt(0)
    v_mfma_f32_32x32x16_bf16 v[48:63], v[104:107], v[8:11], v[16:31]
    ds_read_b128 v[96:99], v128 offset:21504
    ds_read_b32 v100, v129 offset:21504
    v_exp_f32 v32, v32
    v_exp_f32 v33, v33
    v_exp_f32 v34, v34
    v_exp_f32 v35, v35
    v_mfma_f32_32x32x16_bf16 v[64:79], v[120:123], v[88:91], v[64:79]
    ds_read_b128 v[112:115], v130 offset:16128
    ds_read_b128 v[116:119], v130 offset:16832
    v_exp_f32 v36, v36
    v_exp_f32 v37, v37
    v_exp_f32 v38, v38
    v_exp_f32 v39, v39
    v_cvt_pk_bf16_f32 v80, v32, v33
    v_cvt_pk_bf16_f32 v81, v34, v35
    v_cvt_pk_bf16_f32 v82, v36, v37
    v_cvt_pk_bf16_f32 v83, v38, v39
    v_mfma_f32_32x32x16_bf16 v[48:63], v[108:111], v[12:15], v[48:63]
    v_exp_f32 v40, v40
    v_exp_f32 v41, v41
    v_exp_f32 v42, v42
    v_exp_f32 v43, v43
    v_mfma_f32_32x32x16_bf16 v[64:79], v[124:127], v[92:95], v[64:79]
    v_exp_f32 v44, v44
    v_exp_f32 v45, v45
    v_exp_f32 v46, v46
    v_exp_f32 v47, v47
    v_cvt_pk_bf16_f32 v84, v40, v41
    v_cvt_pk_bf16_f32 v85, v42, v43
    v_cvt_pk_bf16_f32 v86, v44, v45
    v_cvt_pk_bf16_f32 v87, v46, v47
    s_waitcnt lgkmcnt(0)
    v_mfma_f32_32x32x16_bf16 v[32:47], v[96:99], v[8:11], v[16:31]
    ds_read_b128 v[104:107], v128 offset:24192
    ds_read_b32 v108, v129 offset:24192
    v_exp_f32 v48, v48
    v_exp_f32 v49, v49
    v_exp_f32 v50, v50
    v_exp_f32 v51, v51
    v_mfma_f32_32x32x16_bf16 v[64:79], v[112:115], v[80:83], v[64:79]
    ds_read_b128 v[120:123], v130 offset:18816
    ds_read_b128 v[124:127], v130 offset:19520
    v_exp_f32 v52, v52
    v_exp_f32 v53, v53
    v_exp_f32 v54, v54
    v_exp_f32 v55, v55
    v_cvt_pk_bf16_f32 v88, v48, v49
    v_cvt_pk_bf16_f32 v89, v50, v51
    v_cvt_pk_bf16_f32 v90, v52, v53
    v_cvt_pk_bf16_f32 v91, v54, v55
    v_mfma_f32_32x32x16_bf16 v[32:47], v[100:103], v[12:15], v[32:47]
    v_exp_f32 v56, v56
    v_exp_f32 v57, v57
    v_exp_f32 v58, v58
    v_exp_f32 v59, v59
    v_mfma_f32_32x32x16_bf16 v[64:79], v[116:119], v[84:87], v[64:79]
    v_exp_f32 v60, v60
    v_exp_f32 v61, v61
    v_exp_f32 v62, v62
    v_exp_f32 v63, v63
    v_cvt_pk_bf16_f32 v92, v56, v57
    v_cvt_pk_bf16_f32 v93, v58, v59
    v_cvt_pk_bf16_f32 v94, v60, v61
    v_cvt_pk_bf16_f32 v95, v62, v63
    s_waitcnt lgkmcnt(0)
    v_mfma_f32_32x32x16_bf16 v[48:63], v[104:107], v[8:11], v[16:31]
    ds_read_b128 v[96:99], v128 offset:26880
    ds_read_b32 v100, v129 offset:26880
    v_exp_f32 v32, v32
    v_exp_f32 v33, v33
    v_exp_f32 v34, v34
    v_exp_f32 v35, v35
    v_mfma_f32_32x32x16_bf16 v[64:79], v[120:123], v[88:91], v[64:79]
    ds_read_b128 v[112:115], v130 offset:21504
    ds_read_b128 v[116:119], v130 offset:22208
    v_exp_f32 v36, v36
    v_exp_f32 v37, v37
    v_exp_f32 v38, v38
    v_exp_f32 v39, v39
    v_cvt_pk_bf16_f32 v80, v32, v33
    v_cvt_pk_bf16_f32 v81, v34, v35
    v_cvt_pk_bf16_f32 v82, v36, v37
    v_cvt_pk_bf16_f32 v83, v38, v39
    v_mfma_f32_32x32x16_bf16 v[48:63], v[108:111], v[12:15], v[48:63]
    v_exp_f32 v40, v40
    v_exp_f32 v41, v41
    v_exp_f32 v42, v42
    v_exp_f32 v43, v43
    v_mfma_f32_32x32x16_bf16 v[64:79], v[124:127], v[92:95], v[64:79]
    v_exp_f32 v44, v44
    v_exp_f32 v45, v45
    v_exp_f32 v46, v46
    v_exp_f32 v47, v47
    v_cvt_pk_bf16_f32 v84, v40, v41
    v_cvt_pk_bf16_f32 v85, v42, v43
    v_cvt_pk_bf16_f32 v86, v44, v45
    v_cvt_pk_bf16_f32 v87, v46, v47
    s_cmp_ge_u32 s32, 4
    s_cbranch_scc1 L_attn0_kernel_w3
    s_mov_b32 m0, s61
    s_add_u32 s45, s61, 4096
    buffer_load_dwordx4 v208, s[20:23], s60 offen offset:0 lds
    buffer_load_dwordx4 v209, s[20:23], s60 offen offset:1024 lds
    buffer_load_dwordx4 v210, s[20:23], s60 offen offset:2048 lds
    buffer_load_dwordx4 v211, s[20:23], s60 offen offset:3072 lds
    s_mov_b32 m0, s45
    s_nop 0
    buffer_load_dwordx4 v212, s[20:23], s60 offen lds
    s_branch L_attn0_kernel_w4
L_attn0_kernel_w3:
    s_cmp_ge_u32 s32, 6
    s_cbranch_scc1 L_attn0_kernel_w4
    s_sub_u32 s43, s32, 4
    s_mul_i32 s60, s43, 40960
    s_mul_i32 s44, s58, 81920
    s_add_u32 s60, s60, s44
    s_mul_i32 s61, s43, 5120
    s_add_u32 s61, s61, 102400
    s_mov_b32 m0, s61
    s_add_u32 s45, s61, 4096
    buffer_load_dwordx4 v208, s[16:19], s60 offen offset:0 lds
    buffer_load_dwordx4 v209, s[16:19], s60 offen offset:1024 lds
    buffer_load_dwordx4 v210, s[16:19], s60 offen offset:2048 lds
    buffer_load_dwordx4 v211, s[16:19], s60 offen offset:3072 lds
    s_mov_b32 m0, s45
    s_nop 0
    buffer_load_dwordx4 v212, s[16:19], s60 offen lds
L_attn0_kernel_w4:
    s_waitcnt lgkmcnt(0)
    v_mfma_f32_32x32x16_bf16 v[32:47], v[96:99], v[8:11], v[16:31]
    ds_read_b128 v[104:107], v128 offset:29568
    ds_read_b32 v108, v129 offset:29568
    v_exp_f32 v48, v48
    v_exp_f32 v49, v49
    v_exp_f32 v50, v50
    v_exp_f32 v51, v51
    v_mfma_f32_32x32x16_bf16 v[64:79], v[112:115], v[80:83], v[64:79]
    ds_read_b128 v[120:123], v130 offset:24192
    ds_read_b128 v[124:127], v130 offset:24896
    v_exp_f32 v52, v52
    v_exp_f32 v53, v53
    v_exp_f32 v54, v54
    v_exp_f32 v55, v55
    v_cvt_pk_bf16_f32 v88, v48, v49
    v_cvt_pk_bf16_f32 v89, v50, v51
    v_cvt_pk_bf16_f32 v90, v52, v53
    v_cvt_pk_bf16_f32 v91, v54, v55
    v_mfma_f32_32x32x16_bf16 v[32:47], v[100:103], v[12:15], v[32:47]
    v_exp_f32 v56, v56
    v_exp_f32 v57, v57
    v_exp_f32 v58, v58
    v_exp_f32 v59, v59
    v_mfma_f32_32x32x16_bf16 v[64:79], v[116:119], v[84:87], v[64:79]
    v_exp_f32 v60, v60
    v_exp_f32 v61, v61
    v_exp_f32 v62, v62
    v_exp_f32 v63, v63
    v_cvt_pk_bf16_f32 v92, v56, v57
    v_cvt_pk_bf16_f32 v93, v58, v59
    v_cvt_pk_bf16_f32 v94, v60, v61
    v_cvt_pk_bf16_f32 v95, v62, v63
    s_waitcnt lgkmcnt(0)
    v_mfma_f32_32x32x16_bf16 v[48:63], v[104:107], v[8:11], v[16:31]
    v_exp_f32 v32, v32
    v_exp_f32 v33, v33
    v_exp_f32 v34, v34
    v_exp_f32 v35, v35
    v_mfma_f32_32x32x16_bf16 v[64:79], v[120:123], v[88:91], v[64:79]
    ds_read_b128 v[112:115], v130 offset:26880
    ds_read_b128 v[116:119], v130 offset:27584
    v_exp_f32 v36, v36
    v_exp_f32 v37, v37
    v_exp_f32 v38, v38
    v_exp_f32 v39, v39
    v_cvt_pk_bf16_f32 v80, v32, v33
    v_cvt_pk_bf16_f32 v81, v34, v35
    v_cvt_pk_bf16_f32 v82, v36, v37
    v_cvt_pk_bf16_f32 v83, v38, v39
    v_mfma_f32_32x32x16_bf16 v[48:63], v[108:111], v[12:15], v[48:63]
    v_exp_f32 v40, v40
    v_exp_f32 v41, v41
    v_exp_f32 v42, v42
    v_exp_f32 v43, v43
    v_mfma_f32_32x32x16_bf16 v[64:79], v[124:127], v[92:95], v[64:79]
    v_exp_f32 v44, v44
    v_exp_f32 v45, v45
    v_exp_f32 v46, v46
    v_exp_f32 v47, v47
    v_cvt_pk_bf16_f32 v84, v40, v41
    v_cvt_pk_bf16_f32 v85, v42, v43
    v_cvt_pk_bf16_f32 v86, v44, v45
    v_cvt_pk_bf16_f32 v87, v46, v47
    s_waitcnt lgkmcnt(0)
    v_mfma_f32_32x32x16_bf16 v[32:47], v[144:147], v[8:11], v[16:31]
    v_exp_f32 v48, v48
    v_exp_f32 v49, v49
    v_exp_f32 v50, v50
    v_exp_f32 v51, v51
    v_mfma_f32_32x32x16_bf16 v[64:79], v[112:115], v[80:83], v[64:79]
    ds_read_b128 v[120:123], v130 offset:29568
    ds_read_b128 v[124:127], v130 offset:30272
    v_exp_f32 v52, v52
    v_exp_f32 v53, v53
    v_exp_f32 v54, v54
    v_exp_f32 v55, v55
    v_cvt_pk_bf16_f32 v88, v48, v49
    v_cvt_pk_bf16_f32 v89, v50, v51
    v_cvt_pk_bf16_f32 v90, v52, v53
    v_cvt_pk_bf16_f32 v91, v54, v55
    v_mfma_f32_32x32x16_bf16 v[32:47], v[148:151], v[12:15], v[32:47]
    v_exp_f32 v56, v56
    v_exp_f32 v57, v57
    v_exp_f32 v58, v58
    v_exp_f32 v59, v59
    v_mfma_f32_32x32x16_bf16 v[64:79], v[116:119], v[84:87], v[64:79]
    v_exp_f32 v60, v60
    v_exp_f32 v61, v61
    v_exp_f32 v62, v62
    v_exp_f32 v63, v63
    v_cvt_pk_bf16_f32 v92, v56, v57
    v_cvt_pk_bf16_f32 v93, v58, v59
    v_cvt_pk_bf16_f32 v94, v60, v61
    v_cvt_pk_bf16_f32 v95, v62, v63
    s_setprio 0
    s_waitcnt lgkmcnt(0)
    v_mfma_f32_32x32x16_bf16 v[48:63], v[160:163], v[8:11], v[16:31]
    v_exp_f32 v32, v32
    v_exp_f32 v33, v33
    v_exp_f32 v34, v34
    v_exp_f32 v35, v35
    v_mfma_f32_32x32x16_bf16 v[64:79], v[120:123], v[88:91], v[64:79]
    v_exp_f32 v36, v36
    v_exp_f32 v37, v37
    v_exp_f32 v38, v38
    v_exp_f32 v39, v39
    v_cvt_pk_bf16_f32 v80, v32, v33
    v_cvt_pk_bf16_f32 v81, v34, v35
    v_cvt_pk_bf16_f32 v82, v36, v37
    v_cvt_pk_bf16_f32 v83, v38, v39
    v_mfma_f32_32x32x16_bf16 v[48:63], v[164:167], v[12:15], v[48:63]
    v_exp_f32 v40, v40
    v_exp_f32 v41, v41
    v_exp_f32 v42, v42
    v_exp_f32 v43, v43
    v_mfma_f32_32x32x16_bf16 v[64:79], v[124:127], v[92:95], v[64:79]
    v_exp_f32 v44, v44
    v_exp_f32 v45, v45
    v_exp_f32 v46, v46
    v_exp_f32 v47, v47
    v_cvt_pk_bf16_f32 v84, v40, v41
    v_cvt_pk_bf16_f32 v85, v42, v43
    v_cvt_pk_bf16_f32 v86, v44, v45
    v_cvt_pk_bf16_f32 v87, v46, v47
    s_waitcnt lgkmcnt(0)
    v_mfma_f32_32x32x16_bf16 v[32:47], v[176:179], v[8:11], v[16:31]
    v_exp_f32 v48, v48
    v_exp_f32 v49, v49
    v_exp_f32 v50, v50
    v_exp_f32 v51, v51
    v_mfma_f32_32x32x16_bf16 v[64:79], v[152:155], v[80:83], v[64:79]
    v_exp_f32 v52, v52
    v_exp_f32 v53, v53
    v_exp_f32 v54, v54
    v_exp_f32 v55, v55
    v_cvt_pk_bf16_f32 v88, v48, v49
    v_cvt_pk_bf16_f32 v89, v50, v51
    v_cvt_pk_bf16_f32 v90, v52, v53
    v_cvt_pk_bf16_f32 v91, v54, v55
    v_mfma_f32_32x32x16_bf16 v[32:47], v[180:183], v[12:15], v[32:47]
    v_exp_f32 v56, v56
    v_exp_f32 v57, v57
    v_exp_f32 v58, v58
    v_exp_f32 v59, v59
    v_mfma_f32_32x32x16_bf16 v[64:79], v[156:159], v[84:87], v[64:79]
    v_exp_f32 v60, v60
    v_exp_f32 v61, v61
    v_exp_f32 v62, v62
    v_exp_f32 v63, v63
    v_cvt_pk_bf16_f32 v92, v56, v57
    v_cvt_pk_bf16_f32 v93, v58, v59
    v_cvt_pk_bf16_f32 v94, v60, v61
    v_cvt_pk_bf16_f32 v95, v62, v63
    s_waitcnt lgkmcnt(0)
    v_mfma_f32_32x32x16_bf16 v[48:63], v[192:195], v[8:11], v[16:31]
    v_exp_f32 v32, v32
    v_exp_f32 v33, v33
    v_exp_f32 v34, v34
    v_exp_f32 v35, v35
    v_mfma_f32_32x32x16_bf16 v[64:79], v[168:171], v[88:91], v[64:79]
    v_exp_f32 v36, v36
    v_exp_f32 v37, v37
    v_exp_f32 v38, v38
    v_exp_f32 v39, v39
    v_cvt_pk_bf16_f32 v80, v32, v33
    v_cvt_pk_bf16_f32 v81, v34, v35
    v_cvt_pk_bf16_f32 v82, v36, v37
    v_cvt_pk_bf16_f32 v83, v38, v39
    v_mfma_f32_32x32x16_bf16 v[48:63], v[196:199], v[12:15], v[48:63]
    v_exp_f32 v40, v40
    v_exp_f32 v41, v41
    v_exp_f32 v42, v42
    v_exp_f32 v43, v43
    v_mfma_f32_32x32x16_bf16 v[64:79], v[172:175], v[92:95], v[64:79]
    v_exp_f32 v44, v44
    v_exp_f32 v45, v45
    v_exp_f32 v46, v46
    v_exp_f32 v47, v47
    v_cvt_pk_bf16_f32 v84, v40, v41
    v_cvt_pk_bf16_f32 v85, v42, v43
    v_cvt_pk_bf16_f32 v86, v44, v45
    v_cvt_pk_bf16_f32 v87, v46, v47
    s_waitcnt lgkmcnt(0)
    v_exp_f32 v48, v48
    v_exp_f32 v49, v49
    v_exp_f32 v50, v50
    v_exp_f32 v51, v51
    v_mfma_f32_32x32x16_bf16 v[64:79], v[184:187], v[80:83], v[64:79]
    v_exp_f32 v52, v52
    v_exp_f32 v53, v53
    v_exp_f32 v54, v54
    v_exp_f32 v55, v55
    v_cvt_pk_bf16_f32 v88, v48, v49
    v_cvt_pk_bf16_f32 v89, v50, v51
    v_cvt_pk_bf16_f32 v90, v52, v53
    v_cvt_pk_bf16_f32 v91, v54, v55
    v_exp_f32 v56, v56
    v_exp_f32 v57, v57
    v_exp_f32 v58, v58
    v_exp_f32 v59, v59
    v_mfma_f32_32x32x16_bf16 v[64:79], v[188:191], v[84:87], v[64:79]
    v_exp_f32 v60, v60
    v_exp_f32 v61, v61
    v_exp_f32 v62, v62
    v_exp_f32 v63, v63
    v_cvt_pk_bf16_f32 v92, v56, v57
    v_cvt_pk_bf16_f32 v93, v58, v59
    v_cvt_pk_bf16_f32 v94, v60, v61
    v_cvt_pk_bf16_f32 v95, v62, v63
    s_setprio 0
    s_nop 1
    v_mfma_f32_32x32x16_bf16 v[64:79], v[200:203], v[88:91], v[64:79]
    v_mfma_f32_32x32x16_bf16 v[64:79], v[204:207], v[92:95], v[64:79]
L_attn0_kernel_check:
    s_nop 15
    s_nop 3
    v_mov_b32 v4, v72
    v_mov_b32 v5, v72
    s_nop 1
    v_permlane32_swap_b32 v4, v5
    v_mov_b32 v6, 0
    v_fma_f32 v6, v64, 0, v6
    v_fma_f32 v6, v65, 0, v6
    v_fma_f32 v6, v66, 0, v6
    v_fma_f32 v6, v67, 0, v6
    v_fma_f32 v6, v68, 0, v6
    v_fma_f32 v6, v69, 0, v6
    v_fma_f32 v6, v70, 0, v6
    v_fma_f32 v6, v71, 0, v6
    v_fma_f32 v6, v72, 0, v6
    v_fma_f32 v6, v73, 0, v6
    v_fma_f32 v6, v74, 0, v6
    v_fma_f32 v6, v75, 0, v6
    v_fma_f32 v6, v5, 0, v6
    s_mov_b32 s43, 0x71800000
    v_cmp_neq_f32 vcc, 0, v6
    v_cmp_nlt_f32 s[46:47], v5, s43
    s_or_b64 vcc, vcc, s[46:47]
    s_cmp_lg_u32 s40, 0
    s_cbranch_scc1 L_attn0_kernel_store
    s_cbranch_vccz L_attn0_kernel_store
    s_mov_b32 s40, 1
    s_branch L_attn0_kernel_restart
L_attn0_kernel_store:
    v_rcp_f32 v5, v5
    s_nop 0
    v_mul_f32 v64, v5, v64
    v_mul_f32 v65, v5, v65
    v_mul_f32 v66, v5, v66
    v_mul_f32 v67, v5, v67
    v_mul_f32 v68, v5, v68
    v_mul_f32 v69, v5, v69
    v_mul_f32 v70, v5, v70
    v_mul_f32 v71, v5, v71
    v_mul_f32 v72, v5, v72
    v_mul_f32 v73, v5, v73
    v_mul_f32 v74, v5, v74
    v_mul_f32 v75, v5, v75
    v_cvt_pk_bf16_f32 v32, v64, v65
    v_cvt_pk_bf16_f32 v33, v66, v67
    v_cvt_pk_bf16_f32 v34, v68, v69
    v_cvt_pk_bf16_f32 v35, v70, v71
    v_cvt_pk_bf16_f32 v36, v72, v73
    v_cvt_pk_bf16_f32 v37, v74, v75
    v_mul_u32_u24 v4, 20, v1
    v_lshl_add_u32 v4, v2, 2, v4
    s_lshl_b32 s36, s32, 4
    s_add_u32 s36, s36, 113664
    v_add_u32 v5, 0, v4
    v_lshrrev_b32 v6, 5, v5
    v_lshlrev_b32 v6, 9, v6
    v_bfe_u32 v7, v5, 2, 2
    v_lshl_add_u32 v6, v7, 7, v6
    v_bfe_u32 v7, v5, 4, 1
    v_lshl_add_u32 v6, v7, 3, v6
    v_add_u32 v10, s36, v6
    v_add_u32 v5, 8, v4
    v_lshrrev_b32 v6, 5, v5
    v_lshlrev_b32 v6, 9, v6
    v_bfe_u32 v7, v5, 2, 2
    v_lshl_add_u32 v6, v7, 7, v6
    v_bfe_u32 v7, v5, 4, 1
    v_lshl_add_u32 v6, v7, 3, v6
    v_add_u32 v11, s36, v6
    v_add_u32 v5, 16, v4
    v_lshrrev_b32 v6, 5, v5
    v_lshlrev_b32 v6, 9, v6
    v_bfe_u32 v7, v5, 2, 2
    v_lshl_add_u32 v6, v7, 7, v6
    v_bfe_u32 v7, v5, 4, 1
    v_lshl_add_u32 v6, v7, 3, v6
    v_add_u32 v12, s36, v6
    ds_write_b64 v10, v[32:33]
    ds_write_b64 v11, v[34:35]
    v_cmp_eq_u32 vcc, 0, v2
    s_and_saveexec_b64 s[46:47], vcc
    ds_write_b64 v12, v[36:37]
    s_mov_b64 exec, -1
    s_lshr_b32 s33, s33, 6
    s_lshr_b32 s34, s2, 5
    v_and_b32 v1, 15, v0
    v_lshrrev_b32 v2, 4, v0
    s_waitcnt lgkmcnt(0)
    s_barrier
    s_lshl_b32 s43, s32, 10
    s_add_u32 s43, s43, 113664
    v_add_u32 v10, s43, v3
    ds_read_b128 v[32:35], v10
    ds_read_b128 v[36:39], v10 offset:8192
    v_lshrrev_b32 v11, 3, v0
    v_lshlrev_b32 v11, 8, v11
    v_and_b32 v12, 7, v0
    v_lshl_add_u32 v11, v12, 4, v11
    s_lshl_b32 s44, s33, 2
    s_lshr_b32 s45, s34, 1
    s_add_u32 s44, s44, s45
    s_mul_i32 s44, s44, 20480
    s_and_b32 s45, s34, 1
    s_lshl_b32 s45, s45, 7
    s_add_u32 s44, s44, s45
    s_lshl_b32 s45, s32, 11
    s_add_u32 s44, s44, s45
    s_add_u32 s44, s44, 4194304
    s_waitcnt lgkmcnt(0)
    buffer_store_dwordx4 v[32:35], v11, s[28:31], s44 offen sc1
    s_cmp_ge_u32 s32, 2
    s_cbranch_scc1 L_attn0_kernel_os
    s_add_u32 s44, s44, 16384
    buffer_store_dwordx4 v[36:39], v11, s[28:31], s44 offen sc1
L_attn0_kernel_os:
    s_waitcnt vmcnt(0)
    s_barrier
    s_lshl_b32 s43, s33, 8
    s_add_u32 s43, s43, 11010048
    v_mov_b32 v10, s43
    v_mov_b32 v11, 1
    s_cmp_lg_u32 s32, 0
    s_cbranch_scc1 L_attn0_kernel_nosig
    s_mov_b64 exec, 1
    buffer_atomic_add v11, v10, s[28:31], 0 offen
    s_mov_b64 exec, -1
L_attn0_kernel_nosig:
    s_and_b32 s52, s32, 3
    s_lshr_b32 s53, s32, 2
    s_lshl_b32 s42, s33, 2
    s_add_u32 s42, s42, s52
    s_mul_i32 s49, s42, 20480
    s_mul_i32 s44, s53, 10240
    s_add_u32 s49, s49, s44
    s_add_u32 s49, s49, 4194304
    v_lshrrev_b32 v13, 2, v1
    v_lshl_add_u32 v13, v2, 2, v13
    v_and_b32 v14, 3, v1
    v_lshlrev_b32 v14, 3, v14
    v_mul_u32_u24 v15, 160, v13
    v_add_u32 v20, v15, v14
    s_mul_i32 s48, s52, 2560
    s_add_u32 s48, s48, 102400
    v_add_u32 v22, s48, v20
    s_mul_i32 s48, s53, 51200
    v_add_u32 v20, s48, v20
    v_mov_b32 v24, 0
    v_mov_b32 v25, 0
    v_mov_b32 v26, 0
    v_mov_b32 v27, 0
    v_mov_b32 v28, 0
    v_mov_b32 v29, 0
    v_mov_b32 v30, 0
    v_mov_b32 v31, 0
    v_mov_b32 v32, 0
    v_mov_b32 v33, 0
    v_mov_b32 v34, 0
    v_mov_b32 v35, 0
    v_mov_b32 v36, 0
    v_mov_b32 v37, 0
    v_mov_b32 v38, 0
    v_mov_b32 v39, 0
    v_mov_b32 v40, 0
    v_mov_b32 v41, 0
    v_mov_b32 v42, 0
    v_mov_b32 v43, 0
    ds_read_b64_tr_b16 v[104:105], v20 offset:0
    ds_read_b64_tr_b16 v[106:107], v20 offset:2560
    ds_read_b64_tr_b16 v[108:109], v20 offset:32
    ds_read_b64_tr_b16 v[110:111], v20 offset:2592
    ds_read_b64_tr_b16 v[112:113], v20 offset:64
    ds_read_b64_tr_b16 v[114:115], v20 offset:2624
    ds_read_b64_tr_b16 v[116:117], v20 offset:96
    ds_read_b64_tr_b16 v[118:119], v20 offset:2656
    ds_read_b64_tr_b16 v[120:121], v20 offset:128
    ds_read_b64_tr_b16 v[122:123], v20 offset:2688
    s_cmp_lg_u32 s32, 0
    s_cbranch_scc1 L_attn0_kernel_nopoll
    s_mov_b64 exec, 1
L_attn0_kernel_poll:
    buffer_load_dword v12, v10, s[28:31], 0 offen sc1
    s_waitcnt vmcnt(0)
    v_readfirstlane_b32 s43, v12
    s_cmp_ge_u32 s43, 8
    s_cbranch_scc1 L_attn0_kernel_polled
    s_sleep 1
    s_branch L_attn0_kernel_poll
L_attn0_kernel_polled:
    s_mov_b64 exec, -1
L_attn0_kernel_nopoll:
    s_waitcnt vmcnt(0)
    s_barrier
    buffer_load_dwordx4 v[64:67], v3, s[28:31], s49 offen offset:0 sc1
    buffer_load_dwordx4 v[68:71], v3, s[28:31], s49 offen offset:1024 sc1
    buffer_load_dwordx4 v[72:75], v3, s[28:31], s49 offen offset:2048 sc1
    buffer_load_dwordx4 v[76:79], v3, s[28:31], s49 offen offset:3072 sc1
    s_add_u32 s49, s49, 4096
    buffer_load_dwordx4 v[80:83], v3, s[28:31], s49 offen offset:0 sc1
    buffer_load_dwordx4 v[84:87], v3, s[28:31], s49 offen offset:1024 sc1
    buffer_load_dwordx4 v[88:91], v3, s[28:31], s49 offen offset:2048 sc1
    buffer_load_dwordx4 v[92:95], v3, s[28:31], s49 offen offset:3072 sc1
    s_add_u32 s49, s49, 4096
    buffer_load_dwordx4 v[96:99], v3, s[28:31], s49 offen offset:0 sc1
    buffer_load_dwordx4 v[100:103], v3, s[28:31], s49 offen offset:1024 sc1
    s_waitcnt lgkmcnt(0) vmcnt(9)
    v_mfma_f32_16x16x32_bf16 v[24:27], v[64:67], v[104:107], v[24:27]
    ds_read_b64_tr_b16 v[124:125], v20 offset:5120
    ds_read_b64_tr_b16 v[126:127], v20 offset:7680
    v_mfma_f32_16x16x32_bf16 v[28:31], v[64:67], v[108:111], v[28:31]
    ds_read_b64_tr_b16 v[128:129], v20 offset:5152
    ds_read_b64_tr_b16 v[130:131], v20 offset:7712
    v_mfma_f32_16x16x32_bf16 v[32:35], v[64:67], v[112:115], v[32:35]
    ds_read_b64_tr_b16 v[132:133], v20 offset:5184
    ds_read_b64_tr_b16 v[134:135], v20 offset:7744
    v_mfma_f32_16x16x32_bf16 v[36:39], v[64:67], v[116:119], v[36:39]
    ds_read_b64_tr_b16 v[136:137], v20 offset:5216
    ds_read_b64_tr_b16 v[138:139], v20 offset:7776
    v_mfma_f32_16x16x32_bf16 v[40:43], v[64:67], v[120:123], v[40:43]
    ds_read_b64_tr_b16 v[140:141], v20 offset:5248
    ds_read_b64_tr_b16 v[142:143], v20 offset:7808
    s_waitcnt lgkmcnt(0) vmcnt(8)
    v_mfma_f32_16x16x32_bf16 v[24:27], v[68:71], v[124:127], v[24:27]
    ds_read_b64_tr_b16 v[104:105], v20 offset:10240
    ds_read_b64_tr_b16 v[106:107], v20 offset:12800
    v_mfma_f32_16x16x32_bf16 v[28:31], v[68:71], v[128:131], v[28:31]
    ds_read_b64_tr_b16 v[108:109], v20 offset:10272
    ds_read_b64_tr_b16 v[110:111], v20 offset:12832
    v_mfma_f32_16x16x32_bf16 v[32:35], v[68:71], v[132:135], v[32:35]
    ds_read_b64_tr_b16 v[112:113], v20 offset:10304
    ds_read_b64_tr_b16 v[114:115], v20 offset:12864
    v_mfma_f32_16x16x32_bf16 v[36:39], v[68:71], v[136:139], v[36:39]
    ds_read_b64_tr_b16 v[116:117], v20 offset:10336
    ds_read_b64_tr_b16 v[118:119], v20 offset:12896
    v_mfma_f32_16x16x32_bf16 v[40:43], v[68:71], v[140:143], v[40:43]
    ds_read_b64_tr_b16 v[120:121], v20 offset:10368
    ds_read_b64_tr_b16 v[122:123], v20 offset:12928
    s_waitcnt lgkmcnt(0) vmcnt(7)
    v_mfma_f32_16x16x32_bf16 v[24:27], v[72:75], v[104:107], v[24:27]
    ds_read_b64_tr_b16 v[124:125], v20 offset:15360
    ds_read_b64_tr_b16 v[126:127], v20 offset:17920
    v_mfma_f32_16x16x32_bf16 v[28:31], v[72:75], v[108:111], v[28:31]
    ds_read_b64_tr_b16 v[128:129], v20 offset:15392
    ds_read_b64_tr_b16 v[130:131], v20 offset:17952
    v_mfma_f32_16x16x32_bf16 v[32:35], v[72:75], v[112:115], v[32:35]
    ds_read_b64_tr_b16 v[132:133], v20 offset:15424
    ds_read_b64_tr_b16 v[134:135], v20 offset:17984
    v_mfma_f32_16x16x32_bf16 v[36:39], v[72:75], v[116:119], v[36:39]
    ds_read_b64_tr_b16 v[136:137], v20 offset:15456
    ds_read_b64_tr_b16 v[138:139], v20 offset:18016
    v_mfma_f32_16x16x32_bf16 v[40:43], v[72:75], v[120:123], v[40:43]
    ds_read_b64_tr_b16 v[140:141], v20 offset:15488
    ds_read_b64_tr_b16 v[142:143], v20 offset:18048
    s_waitcnt lgkmcnt(0) vmcnt(6)
    v_mfma_f32_16x16x32_bf16 v[24:27], v[76:79], v[124:127], v[24:27]
    ds_read_b64_tr_b16 v[104:105], v20 offset:20480
    ds_read_b64_tr_b16 v[106:107], v20 offset:23040
    v_mfma_f32_16x16x32_bf16 v[28:31], v[76:79], v[128:131], v[28:31]
    ds_read_b64_tr_b16 v[108:109], v20 offset:20512
    ds_read_b64_tr_b16 v[110:111], v20 offset:23072
    v_mfma_f32_16x16x32_bf16 v[32:35], v[76:79], v[132:135], v[32:35]
    ds_read_b64_tr_b16 v[112:113], v20 offset:20544
    ds_read_b64_tr_b16 v[114:115], v20 offset:23104
    v_mfma_f32_16x16x32_bf16 v[36:39], v[76:79], v[136:139], v[36:39]
    ds_read_b64_tr_b16 v[116:117], v20 offset:20576
    ds_read_b64_tr_b16 v[118:119], v20 offset:23136
    v_mfma_f32_16x16x32_bf16 v[40:43], v[76:79], v[140:143], v[40:43]
    ds_read_b64_tr_b16 v[120:121], v20 offset:20608
    ds_read_b64_tr_b16 v[122:123], v20 offset:23168
    s_waitcnt lgkmcnt(0) vmcnt(5)
    v_mfma_f32_16x16x32_bf16 v[24:27], v[80:83], v[104:107], v[24:27]
    ds_read_b64_tr_b16 v[124:125], v20 offset:25600
    ds_read_b64_tr_b16 v[126:127], v20 offset:28160
    v_mfma_f32_16x16x32_bf16 v[28:31], v[80:83], v[108:111], v[28:31]
    ds_read_b64_tr_b16 v[128:129], v20 offset:25632
    ds_read_b64_tr_b16 v[130:131], v20 offset:28192
    v_mfma_f32_16x16x32_bf16 v[32:35], v[80:83], v[112:115], v[32:35]
    ds_read_b64_tr_b16 v[132:133], v20 offset:25664
    ds_read_b64_tr_b16 v[134:135], v20 offset:28224
    v_mfma_f32_16x16x32_bf16 v[36:39], v[80:83], v[116:119], v[36:39]
    ds_read_b64_tr_b16 v[136:137], v20 offset:25696
    ds_read_b64_tr_b16 v[138:139], v20 offset:28256
    v_mfma_f32_16x16x32_bf16 v[40:43], v[80:83], v[120:123], v[40:43]
    ds_read_b64_tr_b16 v[140:141], v20 offset:25728
    ds_read_b64_tr_b16 v[142:143], v20 offset:28288
    s_waitcnt lgkmcnt(0) vmcnt(4)
    v_mfma_f32_16x16x32_bf16 v[24:27], v[84:87], v[124:127], v[24:27]
    ds_read_b64_tr_b16 v[104:105], v20 offset:30720
    ds_read_b64_tr_b16 v[106:107], v20 offset:33280
    v_mfma_f32_16x16x32_bf16 v[28:31], v[84:87], v[128:131], v[28:31]
    ds_read_b64_tr_b16 v[108:109], v20 offset:30752
    ds_read_b64_tr_b16 v[110:111], v20 offset:33312
    v_mfma_f32_16x16x32_bf16 v[32:35], v[84:87], v[132:135], v[32:35]
    ds_read_b64_tr_b16 v[112:113], v20 offset:30784
    ds_read_b64_tr_b16 v[114:115], v20 offset:33344
    v_mfma_f32_16x16x32_bf16 v[36:39], v[84:87], v[136:139], v[36:39]
    ds_read_b64_tr_b16 v[116:117], v20 offset:30816
    ds_read_b64_tr_b16 v[118:119], v20 offset:33376
    v_mfma_f32_16x16x32_bf16 v[40:43], v[84:87], v[140:143], v[40:43]
    ds_read_b64_tr_b16 v[120:121], v20 offset:30848
    ds_read_b64_tr_b16 v[122:123], v20 offset:33408
    s_waitcnt lgkmcnt(0) vmcnt(3)
    v_mfma_f32_16x16x32_bf16 v[24:27], v[88:91], v[104:107], v[24:27]
    ds_read_b64_tr_b16 v[124:125], v20 offset:35840
    ds_read_b64_tr_b16 v[126:127], v20 offset:38400
    v_mfma_f32_16x16x32_bf16 v[28:31], v[88:91], v[108:111], v[28:31]
    ds_read_b64_tr_b16 v[128:129], v20 offset:35872
    ds_read_b64_tr_b16 v[130:131], v20 offset:38432
    v_mfma_f32_16x16x32_bf16 v[32:35], v[88:91], v[112:115], v[32:35]
    ds_read_b64_tr_b16 v[132:133], v20 offset:35904
    ds_read_b64_tr_b16 v[134:135], v20 offset:38464
    v_mfma_f32_16x16x32_bf16 v[36:39], v[88:91], v[116:119], v[36:39]
    ds_read_b64_tr_b16 v[136:137], v20 offset:35936
    ds_read_b64_tr_b16 v[138:139], v20 offset:38496
    v_mfma_f32_16x16x32_bf16 v[40:43], v[88:91], v[120:123], v[40:43]
    ds_read_b64_tr_b16 v[140:141], v20 offset:35968
    ds_read_b64_tr_b16 v[142:143], v20 offset:38528
    s_waitcnt lgkmcnt(0) vmcnt(2)
    v_mfma_f32_16x16x32_bf16 v[24:27], v[92:95], v[124:127], v[24:27]
    ds_read_b64_tr_b16 v[104:105], v20 offset:40960
    ds_read_b64_tr_b16 v[106:107], v20 offset:43520
    v_mfma_f32_16x16x32_bf16 v[28:31], v[92:95], v[128:131], v[28:31]
    ds_read_b64_tr_b16 v[108:109], v20 offset:40992
    ds_read_b64_tr_b16 v[110:111], v20 offset:43552
    v_mfma_f32_16x16x32_bf16 v[32:35], v[92:95], v[132:135], v[32:35]
    ds_read_b64_tr_b16 v[112:113], v20 offset:41024
    ds_read_b64_tr_b16 v[114:115], v20 offset:43584
    v_mfma_f32_16x16x32_bf16 v[36:39], v[92:95], v[136:139], v[36:39]
    ds_read_b64_tr_b16 v[116:117], v20 offset:41056
    ds_read_b64_tr_b16 v[118:119], v20 offset:43616
    v_mfma_f32_16x16x32_bf16 v[40:43], v[92:95], v[140:143], v[40:43]
    ds_read_b64_tr_b16 v[120:121], v20 offset:41088
    ds_read_b64_tr_b16 v[122:123], v20 offset:43648
    s_waitcnt lgkmcnt(0) vmcnt(1)
    v_mfma_f32_16x16x32_bf16 v[24:27], v[96:99], v[104:107], v[24:27]
    ds_read_b64_tr_b16 v[124:125], v20 offset:46080
    ds_read_b64_tr_b16 v[126:127], v20 offset:48640
    v_mfma_f32_16x16x32_bf16 v[28:31], v[96:99], v[108:111], v[28:31]
    ds_read_b64_tr_b16 v[128:129], v20 offset:46112
    ds_read_b64_tr_b16 v[130:131], v20 offset:48672
    v_mfma_f32_16x16x32_bf16 v[32:35], v[96:99], v[112:115], v[32:35]
    ds_read_b64_tr_b16 v[132:133], v20 offset:46144
    ds_read_b64_tr_b16 v[134:135], v20 offset:48704
    v_mfma_f32_16x16x32_bf16 v[36:39], v[96:99], v[116:119], v[36:39]
    ds_read_b64_tr_b16 v[136:137], v20 offset:46176
    ds_read_b64_tr_b16 v[138:139], v20 offset:48736
    v_mfma_f32_16x16x32_bf16 v[40:43], v[96:99], v[120:123], v[40:43]
    ds_read_b64_tr_b16 v[140:141], v20 offset:46208
    ds_read_b64_tr_b16 v[142:143], v20 offset:48768
    s_waitcnt lgkmcnt(0) vmcnt(0)
    v_mfma_f32_16x16x32_bf16 v[24:27], v[100:103], v[124:127], v[24:27]
    v_mfma_f32_16x16x32_bf16 v[28:31], v[100:103], v[128:131], v[28:31]
    v_mfma_f32_16x16x32_bf16 v[32:35], v[100:103], v[132:135], v[32:35]
    v_mfma_f32_16x16x32_bf16 v[36:39], v[100:103], v[136:139], v[36:39]
    v_mfma_f32_16x16x32_bf16 v[40:43], v[100:103], v[140:143], v[40:43]
    s_mul_i32 s44, s52, 5120
    s_add_u32 s44, s44, 112640
    v_add_u32 v10, s44, v3
    s_cmp_eq_u32 s53, 0
    s_cbranch_scc1 L_attn0_kernel_kh0
    s_nop 7
    ds_write_b128 v10, v[24:27] offset:0
    ds_write_b128 v10, v[28:31] offset:1024
    ds_write_b128 v10, v[32:35] offset:2048
    ds_write_b128 v10, v[36:39] offset:3072
    ds_write_b128 v10, v[40:43] offset:4096
    s_waitcnt lgkmcnt(0)
    s_barrier
    s_branch L_attn0_kernel_fin
L_attn0_kernel_kh0:
    ds_read_b64_tr_b16 v[144:145], v22 offset:0
    ds_read_b64_tr_b16 v[146:147], v22 offset:32
    ds_read_b64_tr_b16 v[148:149], v22 offset:64
    ds_read_b64_tr_b16 v[150:151], v22 offset:96
    ds_read_b64_tr_b16 v[152:153], v22 offset:128
    v_mov_b32 v44, 0
    v_mov_b32 v45, 0
    v_mov_b32 v46, 0
    v_mov_b32 v47, 0
    v_mov_b32 v48, 0
    v_mov_b32 v49, 0
    v_mov_b32 v50, 0
    v_mov_b32 v51, 0
    s_mul_i32 s44, s34, 327680
    s_lshr_b32 s45, s42, 1
    s_lshl_b32 s45, s45, 10
    s_add_u32 s44, s44, s45
    s_and_b32 s45, s42, 1
    s_lshl_b32 s45, s45, 3
    s_add_u32 s44, s44, s45
    s_add_u32 s44, s44, 7340032
    s_mov_b32 s46, 0xffff0000
    s_barrier
    ds_read_b128 v[64:67], v10 offset:0
    ds_read_b128 v[68:71], v10 offset:1024
    ds_read_b128 v[72:75], v10 offset:2048
    ds_read_b128 v[76:79], v10 offset:3072
    ds_read_b128 v[80:83], v10 offset:4096
    s_waitcnt lgkmcnt(0)
    v_add_f32 v24, v24, v64
    v_add_f32 v25, v25, v65
    v_add_f32 v26, v26, v66
    v_add_f32 v27, v27, v67
    v_add_f32 v28, v28, v68
    v_add_f32 v29, v29, v69
    v_add_f32 v30, v30, v70
    v_add_f32 v31, v31, v71
    v_add_f32 v32, v32, v72
    v_add_f32 v33, v33, v73
    v_add_f32 v34, v34, v74
    v_add_f32 v35, v35, v75
    v_add_f32 v36, v36, v76
    v_add_f32 v37, v37, v77
    v_add_f32 v38, v38, v78
    v_add_f32 v39, v39, v79
    v_add_f32 v40, v40, v80
    v_add_f32 v41, v41, v81
    v_add_f32 v42, v42, v82
    v_add_f32 v43, v43, v83
    v_lshlrev_b32 v52, 16, v144
    v_and_b32 v53, s46, v144
    v_add_f32 v52, v52, v24
    v_add_f32 v53, v53, v25
    v_cvt_pk_bf16_f32 v160, v52, v53
    v_lshlrev_b32 v52, 16, v160
    v_and_b32 v53, s46, v160
    v_add_f32 v44, v44, v52
    v_add_f32 v45, v45, v53
    v_fma_f32 v48, v52, v52, v48
    v_fma_f32 v49, v53, v53, v49
    v_lshlrev_b32 v52, 16, v145
    v_and_b32 v53, s46, v145
    v_add_f32 v52, v52, v26
    v_add_f32 v53, v53, v27
    v_cvt_pk_bf16_f32 v161, v52, v53
    v_lshlrev_b32 v52, 16, v161
    v_and_b32 v53, s46, v161
    v_add_f32 v46, v46, v52
    v_add_f32 v47, v47, v53
    v_fma_f32 v50, v52, v52, v50
    v_fma_f32 v51, v53, v53, v51
    buffer_store_dwordx2 v[160:161], v3, s[28:31], s44 offen
    s_add_u32 s44, s44, 65536
    v_lshlrev_b32 v52, 16, v146
    v_and_b32 v53, s46, v146
    v_add_f32 v52, v52, v28
    v_add_f32 v53, v53, v29
    v_cvt_pk_bf16_f32 v162, v52, v53
    v_lshlrev_b32 v52, 16, v162
    v_and_b32 v53, s46, v162
    v_add_f32 v44, v44, v52
    v_add_f32 v45, v45, v53
    v_fma_f32 v48, v52, v52, v48
    v_fma_f32 v49, v53, v53, v49
    v_lshlrev_b32 v52, 16, v147
    v_and_b32 v53, s46, v147
    v_add_f32 v52, v52, v30
    v_add_f32 v53, v53, v31
    v_cvt_pk_bf16_f32 v163, v52, v53
    v_lshlrev_b32 v52, 16, v163
    v_and_b32 v53, s46, v163
    v_add_f32 v46, v46, v52
    v_add_f32 v47, v47, v53
    v_fma_f32 v50, v52, v52, v50
    v_fma_f32 v51, v53, v53, v51
    buffer_store_dwordx2 v[162:163], v3, s[28:31], s44 offen
    s_add_u32 s44, s44, 65536
    v_lshlrev_b32 v52, 16, v148
    v_and_b32 v53, s46, v148
    v_add_f32 v52, v52, v32
    v_add_f32 v53, v53, v33
    v_cvt_pk_bf16_f32 v164, v52, v53
    v_lshlrev_b32 v52, 16, v164
    v_and_b32 v53, s46, v164
    v_add_f32 v44, v44, v52
    v_add_f32 v45, v45, v53
    v_fma_f32 v48, v52, v52, v48
    v_fma_f32 v49, v53, v53, v49
    v_lshlrev_b32 v52, 16, v149
    v_and_b32 v53, s46, v149
    v_add_f32 v52, v52, v34
    v_add_f32 v53, v53, v35
    v_cvt_pk_bf16_f32 v165, v52, v53
    v_lshlrev_b32 v52, 16, v165
    v_and_b32 v53, s46, v165
    v_add_f32 v46, v46, v52
    v_add_f32 v47, v47, v53
    v_fma_f32 v50, v52, v52, v50
    v_fma_f32 v51, v53, v53, v51
    buffer_store_dwordx2 v[164:165], v3, s[28:31], s44 offen
    s_add_u32 s44, s44, 65536
    v_lshlrev_b32 v52, 16, v150
    v_and_b32 v53, s46, v150
    v_add_f32 v52, v52, v36
    v_add_f32 v53, v53, v37
    v_cvt_pk_bf16_f32 v166, v52, v53
    v_lshlrev_b32 v52, 16, v166
    v_and_b32 v53, s46, v166
    v_add_f32 v44, v44, v52
    v_add_f32 v45, v45, v53
    v_fma_f32 v48, v52, v52, v48
    v_fma_f32 v49, v53, v53, v49
    v_lshlrev_b32 v52, 16, v151
    v_and_b32 v53, s46, v151
    v_add_f32 v52, v52, v38
    v_add_f32 v53, v53, v39
    v_cvt_pk_bf16_f32 v167, v52, v53
    v_lshlrev_b32 v52, 16, v167
    v_and_b32 v53, s46, v167
    v_add_f32 v46, v46, v52
    v_add_f32 v47, v47, v53
    v_fma_f32 v50, v52, v52, v50
    v_fma_f32 v51, v53, v53, v51
    buffer_store_dwordx2 v[166:167], v3, s[28:31], s44 offen
    s_add_u32 s44, s44, 65536
    v_lshlrev_b32 v52, 16, v152
    v_and_b32 v53, s46, v152
    v_add_f32 v52, v52, v40
    v_add_f32 v53, v53, v41
    v_cvt_pk_bf16_f32 v168, v52, v53
    v_lshlrev_b32 v52, 16, v168
    v_and_b32 v53, s46, v168
    v_add_f32 v44, v44, v52
    v_add_f32 v45, v45, v53
    v_fma_f32 v48, v52, v52, v48
    v_fma_f32 v49, v53, v53, v49
    v_lshlrev_b32 v52, 16, v153
    v_and_b32 v53, s46, v153
    v_add_f32 v52, v52, v42
    v_add_f32 v53, v53, v43
    v_cvt_pk_bf16_f32 v169, v52, v53
    v_lshlrev_b32 v52, 16, v169
    v_and_b32 v53, s46, v169
    v_add_f32 v46, v46, v52
    v_add_f32 v47, v47, v53
    v_fma_f32 v50, v52, v52, v50
    v_fma_f32 v51, v53, v53, v51
    buffer_store_dwordx2 v[168:169], v3, s[28:31], s44 offen
    s_nop 1
    v_add_f32_dpp v44, v44, v44 row_ror:8 row_mask:0xf bank_mask:0xf
    v_add_f32_dpp v45, v45, v45 row_ror:8 row_mask:0xf bank_mask:0xf
    v_add_f32_dpp v46, v46, v46 row_ror:8 row_mask:0xf bank_mask:0xf
    v_add_f32_dpp v47, v47, v47 row_ror:8 row_mask:0xf bank_mask:0xf
    v_add_f32_dpp v48, v48, v48 row_ror:8 row_mask:0xf bank_mask:0xf
    v_add_f32_dpp v49, v49, v49 row_ror:8 row_mask:0xf bank_mask:0xf
    v_add_f32_dpp v50, v50, v50 row_ror:8 row_mask:0xf bank_mask:0xf
    v_add_f32_dpp v51, v51, v51 row_ror:8 row_mask:0xf bank_mask:0xf
    s_nop 1
    v_add_f32_dpp v44, v44, v44 row_ror:4 row_mask:0xf bank_mask:0xf
    v_add_f32_dpp v45, v45, v45 row_ror:4 row_mask:0xf bank_mask:0xf
    v_add_f32_dpp v46, v46, v46 row_ror:4 row_mask:0xf bank_mask:0xf
    v_add_f32_dpp v47, v47, v47 row_ror:4 row_mask:0xf bank_mask:0xf
    v_add_f32_dpp v48, v48, v48 row_ror:4 row_mask:0xf bank_mask:0xf
    v_add_f32_dpp v49, v49, v49 row_ror:4 row_mask:0xf bank_mask:0xf
    v_add_f32_dpp v50, v50, v50 row_ror:4 row_mask:0xf bank_mask:0xf
    v_add_f32_dpp v51, v51, v51 row_ror:4 row_mask:0xf bank_mask:0xf
    s_nop 1
    v_add_f32_dpp v44, v44, v44 row_ror:2 row_mask:0xf bank_mask:0xf
    v_add_f32_dpp v45, v45, v45 row_ror:2 row_mask:0xf bank_mask:0xf
    v_add_f32_dpp v46, v46, v46 row_ror:2 row_mask:0xf bank_mask:0xf
    v_add_f32_dpp v47, v47, v47 row_ror:2 row_mask:0xf bank_mask:0xf
    v_add_f32_dpp v48, v48, v48 row_ror:2 row_mask:0xf bank_mask:0xf
    v_add_f32_dpp v49, v49, v49 row_ror:2 row_mask:0xf bank_mask:0xf
    v_add_f32_dpp v50, v50, v50 row_ror:2 row_mask:0xf bank_mask:0xf
    v_add_f32_dpp v51, v51, v51 row_ror:2 row_mask:0xf bank_mask:0xf
    s_nop 1
    v_add_f32_dpp v44, v44, v44 row_ror:1 row_mask:0xf bank_mask:0xf
    v_add_f32_dpp v45, v45, v45 row_ror:1 row_mask:0xf bank_mask:0xf
    v_add_f32_dpp v46, v46, v46 row_ror:1 row_mask:0xf bank_mask:0xf
    v_add_f32_dpp v47, v47, v47 row_ror:1 row_mask:0xf bank_mask:0xf
    v_add_f32_dpp v48, v48, v48 row_ror:1 row_mask:0xf bank_mask:0xf
    v_add_f32_dpp v49, v49, v49 row_ror:1 row_mask:0xf bank_mask:0xf
    v_add_f32_dpp v50, v50, v50 row_ror:1 row_mask:0xf bank_mask:0xf
    v_add_f32_dpp v51, v51, v51 row_ror:1 row_mask:0xf bank_mask:0xf
    s_lshl_b32 s44, s42, 7
    s_add_u32 s44, s44, 10485760
    v_lshlrev_b32 v10, 5, v2
    v_lshl_add_u32 v10, v1, 2, v10
    v_mov_b32 v11, v44
    v_cmp_eq_u32 vcc, 1, v1
    s_nop 1
    v_cndmask_b32 v11, v11, v48, vcc
    v_cmp_eq_u32 vcc, 2, v1
    s_nop 1
    v_cndmask_b32 v11, v11, v45, vcc
    v_cmp_eq_u32 vcc, 3, v1
    s_nop 1
    v_cndmask_b32 v11, v11, v49, vcc
    v_cmp_eq_u32 vcc, 4, v1
    s_nop 1
    v_cndmask_b32 v11, v11, v46, vcc
    v_cmp_eq_u32 vcc, 5, v1
    s_nop 1
    v_cndmask_b32 v11, v11, v50, vcc
    v_cmp_eq_u32 vcc, 6, v1
    s_nop 1
    v_cndmask_b32 v11, v11, v47, vcc
    v_cmp_eq_u32 vcc, 7, v1
    s_nop 1
    v_cndmask_b32 v11, v11, v51, vcc
    v_cmp_gt_u32 vcc, 8, v1
    s_and_saveexec_b64 s[46:47], vcc
    buffer_atomic_add_f32 v11, v10, s[28:31], s44 offen
L_attn0_kernel_fin:
    s_branch L_attn0_kernel_end
L_attn0_kernel_restart:
    v_mov_b32 v7, 0xff800000
    s_mov_b32 s43, 3145728
L_attn0_kernel_mx:
    buffer_load_dwordx4 v[96:99], v3, s[28:31], s43 offen
    buffer_load_dword v100, v135, s[28:31], s43 offen
    s_waitcnt vmcnt(0)
    v_mfma_f32_32x32x16_bf16 v[32:47], v[96:99], v[8:11], 0
    v_mfma_f32_32x32x16_bf16 v[32:47], v[100:103], v[12:15], v[32:47]
    s_nop 15
    s_nop 3
    v_max3_f32 v7, v7, v32, v33
    v_max3_f32 v7, v7, v34, v35
    v_max3_f32 v7, v7, v36, v37
    v_max3_f32 v7, v7, v38, v39
    v_max3_f32 v7, v7, v40, v41
    v_max3_f32 v7, v7, v42, v43
    v_max3_f32 v7, v7, v44, v45
    v_max3_f32 v7, v7, v46, v47
    s_add_u32 s43, s43, 2688
    s_cmp_lt_u32 s43, 3317760
    s_cbranch_scc1 L_attn0_kernel_mx
    v_mov_b32 v4, v7
    v_mov_b32 v5, v7
    s_nop 1
    v_permlane32_swap_b32 v4, v5
    s_nop 1
    v_max_f32 v7, v4, v5
    v_sub_f32 v7, 0, v7
    v_mov_b32 v16, v7
    v_mov_b32 v17, v7
    v_mov_b32 v18, v7
    v_mov_b32 v19, v7
    v_mov_b32 v20, v7
    v_mov_b32 v21, v7
    v_mov_b32 v22, v7
    v_mov_b32 v23, v7
    v_mov_b32 v24, v7
    v_mov_b32 v25, v7
    v_mov_b32 v26, v7
    v_mov_b32 v27, v7
    v_mov_b32 v28, v7
    v_mov_b32 v29, v7
    v_mov_b32 v30, v7
    v_mov_b32 v31, v7
    v_mov_b32 v64, 0
    v_mov_b32 v65, 0
    v_mov_b32 v66, 0
    v_mov_b32 v67, 0
    v_mov_b32 v68, 0
    v_mov_b32 v69, 0
    v_mov_b32 v70, 0
    v_mov_b32 v71, 0
    v_mov_b32 v72, 0
    v_mov_b32 v73, 0
    v_mov_b32 v74, 0
    v_mov_b32 v75, 0
    v_mov_b32 v76, 0
    v_mov_b32 v77, 0
    v_mov_b32 v78, 0
    v_mov_b32 v79, 0
    s_mov_b32 s43, 3145728
L_attn0_kernel_sl:
    buffer_load_dwordx4 v[96:99], v3, s[28:31], s43 offen
    buffer_load_dword v100, v135, s[28:31], s43 offen
    buffer_load_dwordx4 v[112:115], v134, s[28:31], s43 offen
    buffer_load_dwordx4 v[116:119], v134, s[28:31], s43 offen offset:704
    s_waitcnt vmcnt(0)
    v_mfma_f32_32x32x16_bf16 v[32:47], v[96:99], v[8:11], v[16:31]
    v_mfma_f32_32x32x16_bf16 v[32:47], v[100:103], v[12:15], v[32:47]
    s_nop 15
    s_nop 3
    v_exp_f32 v32, v32
    v_exp_f32 v33, v33
    v_exp_f32 v34, v34
    v_exp_f32 v35, v35
    v_exp_f32 v36, v36
    v_exp_f32 v37, v37
    v_exp_f32 v38, v38
    v_exp_f32 v39, v39
    v_exp_f32 v40, v40
    v_exp_f32 v41, v41
    v_exp_f32 v42, v42
    v_exp_f32 v43, v43
    v_exp_f32 v44, v44
    v_exp_f32 v45, v45
    v_exp_f32 v46, v46
    v_exp_f32 v47, v47
    s_nop 0
    v_cvt_pk_bf16_f32 v80, v32, v33
    v_cvt_pk_bf16_f32 v81, v34, v35
    v_cvt_pk_bf16_f32 v82, v36, v37
    v_cvt_pk_bf16_f32 v83, v38, v39
    v_cvt_pk_bf16_f32 v84, v40, v41
    v_cvt_pk_bf16_f32 v85, v42, v43
    v_cvt_pk_bf16_f32 v86, v44, v45
    v_cvt_pk_bf16_f32 v87, v46, v47
    s_nop 1
    v_mfma_f32_32x32x16_bf16 v[64:79], v[112:115], v[80:83], v[64:79]
    v_mfma_f32_32x32x16_bf16 v[64:79], v[116:119], v[84:87], v[64:79]
    s_nop 15
    s_add_u32 s43, s43, 2688
    s_cmp_lt_u32 s43, 3317760
    s_cbranch_scc1 L_attn0_kernel_sl
    s_branch L_attn0_kernel_check
L_attn0_kernel_end:
    s_endpgm
.globl mlp1_0_kernel
.p2align 8
.type mlp1_0_kernel,@function
mlp1_0_kernel:
    s_cmp_ge_u32 s2, 216
    s_cbranch_scc1 L_mlp1_0_kernel_end
    s_load_dwordx4 s[4:7], s[0:1], 48
    s_load_dwordx2 s[12:13], s[0:1], 96
    v_lshrrev_b32 v1, 6, v0
    v_and_b32 v0, 63, v0
    v_readfirstlane_b32 s32, v1
    s_and_b32 s33, s2, 7
    s_mul_i32 s33, s33, 27
    s_lshr_b32 s34, s2, 3
    s_add_u32 s33, s33, s34
    s_lshr_b32 s34, s33, 3
    s_and_b32 s33, s33, 7
    s_load_dwordx2 s[8:9], s[0:1], 64
    v_and_b32 v1, 15, v0
    v_lshrrev_b32 v2, 4, v0
    v_lshlrev_b32 v3, 4, v0
    s_mul_i32 s35, s32, 8
    v_lshrrev_b32 v10, 3, v0
    v_lshrrev_b32 v11, 1, v10
    v_and_b32 v11, 3, v11
    v_lshlrev_b32 v11, 1, v11
    v_and_b32 v12, 7, v0
    v_xor_b32 v12, v12, v11
    s_movk_i32 s38, 3456
    v_mul_lo_u32 v5, v10, s38
    v_lshl_add_u32 v44, v12, 4, v5
    v_add_u32 v45, 26624, v44
    v_add_u32 v46, 53248, v44
    v_add_u32 v47, 79872, v44
    v_add_u32 v20, 65536, v3
    v_add_u32 v21, 131072, v3
    v_add_u32 v22, 196608, v3
    v_add_u32 v23, 262144, v3
    s_mul_i32 s40, s35, 110592
    s_lshl_b32 s41, s34, 7
    s_add_u32 s40, s40, s41
    s_mul_i32 s41, s33, 327680
    s_lshl_b32 s42, s35, 10
    s_add_u32 s41, s41, s42
    s_add_u32 s41, s41, 7340032
    s_mul_i32 s42, s32, 8192
    s_and_b32 s52, s32, 3
    s_lshr_b32 s53, s32, 2
    s_waitcnt lgkmcnt(0)
    s_mov_b32 s20, s4
    s_and_b32 s21, s5, 0xffff
    s_mov_b32 s22, 0x6c0000
    s_mov_b32 s23, 0x00020000
    s_mov_b32 s28, s12
    s_and_b32 s29, s13, 0xffff
    s_mov_b32 s30, 0x10000000
    s_mov_b32 s31, 0x00020000
    s_lshl_b32 s37, s32, 11
    s_add_u32 s37, s37, 10485760
    v_lshlrev_b32 v4, 3, v0
    buffer_load_dwordx2 v[36:37], v4, s[28:31], s37 offen offset:0
    buffer_load_dwordx2 v[38:39], v4, s[28:31], s37 offen offset:512
    buffer_load_dwordx2 v[40:41], v4, s[28:31], s37 offen offset:1024
    buffer_load_dwordx2 v[42:43], v4, s[28:31], s37 offen offset:1536
    s_add_u32 s64, s42, 0
    s_add_u32 s65, s42, 4096
    buffer_load_dwordx4 v[48:51], v3, s[28:31], s41 offen
    buffer_load_dwordx4 v[52:55], v20, s[28:31], s41 offen
    buffer_load_dwordx4 v[56:59], v21, s[28:31], s41 offen
    buffer_load_dwordx4 v[60:63], v22, s[28:31], s41 offen
    buffer_load_dwordx4 v[64:67], v23, s[28:31], s41 offen
    s_add_u32 s41, s41, 1024
    s_mov_b32 m0, s64
    s_nop 0
    buffer_load_dwordx4 v44, s[20:23], s40 offen offset:0 lds
    buffer_load_dwordx4 v45, s[20:23], s40 offen offset:1024 lds
    buffer_load_dwordx4 v46, s[20:23], s40 offen offset:2048 lds
    buffer_load_dwordx4 v47, s[20:23], s40 offen offset:3072 lds
    s_add_u32 s40, s40, 110592
    s_mov_b32 s24, s6
    s_and_b32 s25, s7, 0xffff
    s_mov_b32 s26, 0xd80
    s_mov_b32 s27, 0x00020000
    s_lshl_b32 s43, s34, 7
    s_lshl_b32 s44, s52, 5
    s_add_u32 s43, s43, s44
    v_lshlrev_b32 v10, 3, v2
    buffer_load_dwordx2 v[24:25], v10, s[24:27], s43 offen
    buffer_load_dwordx4 v[68:71], v3, s[28:31], s41 offen
    buffer_load_dwordx4 v[72:75], v20, s[28:31], s41 offen
    buffer_load_dwordx4 v[76:79], v21, s[28:31], s41 offen
    buffer_load_dwordx4 v[80:83], v22, s[28:31], s41 offen
    buffer_load_dwordx4 v[84:87], v23, s[28:31], s41 offen
    s_add_u32 s41, s41, 1024
    s_mov_b32 m0, s65
    s_nop 0
    buffer_load_dwordx4 v44, s[20:23], s40 offen offset:0 lds
    buffer_load_dwordx4 v45, s[20:23], s40 offen offset:1024 lds
    buffer_load_dwordx4 v46, s[20:23], s40 offen offset:2048 lds
    buffer_load_dwordx4 v47, s[20:23], s40 offen offset:3072 lds
    s_add_u32 s40, s40, 110592
    v_lshrrev_b32 v10, 2, v1
    v_lshl_add_u32 v10, v2, 2, v10
    v_lshrrev_b32 v11, 1, v10
    v_and_b32 v11, 3, v11
    v_and_b32 v12, 3, v1
    v_lshlrev_b32 v12, 3, v12
    v_lshl_add_u32 v12, v10, 7, v12
    v_add_u32 v12, s42, v12
    v_xor_b32 v13, 0, v11
    v_lshl_add_u32 v6, v13, 5, v12
    v_xor_b32 v13, 1, v11
    v_lshl_add_u32 v7, v13, 5, v12
    v_xor_b32 v13, 2, v11
    v_lshl_add_u32 v8, v13, 5, v12
    v_xor_b32 v13, 3, v11
    v_lshl_add_u32 v9, v13, 5, v12
    v_accvgpr_write_b32 a0, 0
    v_accvgpr_write_b32 a1, 0
    v_accvgpr_write_b32 a2, 0
    v_accvgpr_write_b32 a3, 0
    v_accvgpr_write_b32 a4, 0
    v_accvgpr_write_b32 a5, 0
    v_accvgpr_write_b32 a6, 0
    v_accvgpr_write_b32 a7, 0
    v_accvgpr_write_b32 a8, 0
    v_accvgpr_write_b32 a9, 0
    v_accvgpr_write_b32 a10, 0
    v_accvgpr_write_b32 a11, 0
    v_accvgpr_write_b32 a12, 0
    v_accvgpr_write_b32 a13, 0
    v_accvgpr_write_b32 a14, 0
    v_accvgpr_write_b32 a15, 0
    v_accvgpr_write_b32 a16, 0
    v_accvgpr_write_b32 a17, 0
    v_accvgpr_write_b32 a18, 0
    v_accvgpr_write_b32 a19, 0
    v_accvgpr_write_b32 a20, 0
    v_accvgpr_write_b32 a21, 0
    v_accvgpr_write_b32 a22, 0
    v_accvgpr_write_b32 a23, 0
    v_accvgpr_write_b32 a24, 0
    v_accvgpr_write_b32 a25, 0
    v_accvgpr_write_b32 a26, 0
    v_accvgpr_write_b32 a27, 0
    v_accvgpr_write_b32 a28, 0
    v_accvgpr_write_b32 a29, 0
    v_accvgpr_write_b32 a30, 0
    v_accvgpr_write_b32 a31, 0
    v_accvgpr_write_b32 a32, 0
    v_accvgpr_write_b32 a33, 0
    v_accvgpr_write_b32 a34, 0
    v_accvgpr_write_b32 a35, 0
    v_accvgpr_write_b32 a36, 0
    v_accvgpr_write_b32 a37, 0
    v_accvgpr_write_b32 a38, 0
    v_accvgpr_write_b32 a39, 0
    v_accvgpr_write_b32 a40, 0
    v_accvgpr_write_b32 a41, 0
    v_accvgpr_write_b32 a42, 0
    v_accvgpr_write_b32 a43, 0
    v_accvgpr_write_b32 a44, 0
    v_accvgpr_write_b32 a45, 0
    v_accvgpr_write_b32 a46, 0
    v_accvgpr_write_b32 a47, 0
    v_accvgpr_write_b32 a48, 0
    v_accvgpr_write_b32 a49, 0
    v_accvgpr_write_b32 a50, 0
    v_accvgpr_write_b32 a51, 0
    v_accvgpr_write_b32 a52, 0
    v_accvgpr_write_b32 a53, 0
    v_accvgpr_write_b32 a54, 0
    v_accvgpr_write_b32 a55, 0
    v_accvgpr_write_b32 a56, 0
    v_accvgpr_write_b32 a57, 0
    v_accvgpr_write_b32 a58, 0
    v_accvgpr_write_b32 a59, 0
    v_accvgpr_write_b32 a60, 0
    v_accvgpr_write_b32 a61, 0
    v_accvgpr_write_b32 a62, 0
    v_accvgpr_write_b32 a63, 0
    v_accvgpr_write_b32 a64, 0
    v_accvgpr_write_b32 a65, 0
    v_accvgpr_write_b32 a66, 0
    v_accvgpr_write_b32 a67, 0
    v_accvgpr_write_b32 a68, 0
    v_accvgpr_write_b32 a69, 0
    v_accvgpr_write_b32 a70, 0
    v_accvgpr_write_b32 a71, 0
    v_accvgpr_write_b32 a72, 0
    v_accvgpr_write_b32 a73, 0
    v_accvgpr_write_b32 a74, 0
    v_accvgpr_write_b32 a75, 0
    v_accvgpr_write_b32 a76, 0
    v_accvgpr_write_b32 a77, 0
    v_accvgpr_write_b32 a78, 0
    v_accvgpr_write_b32 a79, 0
    s_mov_b32 s46, 0xffff0000
    s_waitcnt vmcnt(19)
    s_lshl_b32 s43, s32, 11
    s_add_u32 s43, s43, 65536
    v_lshlrev_b32 v14, 2, v0
    v_add_u32 v14, s43, v14
    v_lshlrev_b32 v15, 4, v2
    v_add_u32 v15, s43, v15
    s_mov_b32 s47, 0x3acccccd
    s_mov_b32 s48, 0x3727c5ac
    v_mul_f32 v36, s47, v36
    v_mul_f32 v37, s47, v37
    v_fma_f32 v37, -v36, v36, v37
    v_max_f32 v37, 0, v37
    v_add_f32 v16, s48, v37
    v_rsq_f32 v16, v16
    s_nop 0
    v_mul_f32 v37, v37, v16
    v_fma_f32 v37, v37, v16, s48
    v_rsq_f32 v37, v37
    s_nop 0
    v_mul_f32 v37, v37, v16
    v_mul_f32 v36, v36, v37
    v_sub_f32 v36, 0, v36
    ds_write_b32 v14, v37 offset:0
    ds_write_b32 v14, v36 offset:1024
    v_mul_f32 v38, s47, v38
    v_mul_f32 v39, s47, v39
    v_fma_f32 v39, -v38, v38, v39
    v_max_f32 v39, 0, v39
    v_add_f32 v16, s48, v39
    v_rsq_f32 v16, v16
    s_nop 0
    v_mul_f32 v39, v39, v16
    v_fma_f32 v39, v39, v16, s48
    v_rsq_f32 v39, v39
    s_nop 0
    v_mul_f32 v39, v39, v16
    v_mul_f32 v38, v38, v39
    v_sub_f32 v38, 0, v38
    ds_write_b32 v14, v39 offset:256
    ds_write_b32 v14, v38 offset:1280
    v_mul_f32 v40, s47, v40
    v_mul_f32 v41, s47, v41
    v_fma_f32 v41, -v40, v40, v41
    v_max_f32 v41, 0, v41
    v_add_f32 v16, s48, v41
    v_rsq_f32 v16, v16
    s_nop 0
    v_mul_f32 v41, v41, v16
    v_fma_f32 v41, v41, v16, s48
    v_rsq_f32 v41, v41
    s_nop 0
    v_mul_f32 v41, v41, v16
    v_mul_f32 v40, v40, v41
    v_sub_f32 v40, 0, v40
    ds_write_b32 v14, v41 offset:512
    ds_write_b32 v14, v40 offset:1536
    v_mul_f32 v42, s47, v42
    v_mul_f32 v43, s47, v43
    v_fma_f32 v43, -v42, v42, v43
    v_max_f32 v43, 0, v43
    v_add_f32 v16, s48, v43
    v_rsq_f32 v16, v16
    s_nop 0
    v_mul_f32 v43, v43, v16
    v_fma_f32 v43, v43, v16, s48
    v_rsq_f32 v43, v43
    s_nop 0
    v_mul_f32 v43, v43, v16
    v_mul_f32 v42, v42, v43
    v_sub_f32 v42, 0, v42
    ds_write_b32 v14, v43 offset:768
    ds_write_b32 v14, v42 offset:1792
    s_waitcnt lgkmcnt(0)
    s_cmp_lt_u32 s32, 4
    s_cbranch_scc1 L_mlp1_0_kernel_np
    s_setprio 1
L_mlp1_0_kernel_np:
    s_waitcnt vmcnt(10)
    ds_read_b128 v[160:163], v15
    ds_read_b128 v[164:167], v15 offset:64
    ds_read_b128 v[168:171], v15 offset:1024
    ds_read_b128 v[172:175], v15 offset:1088
    v_add_u32 v15, 128, v15
    ds_read_b64_tr_b16 v[128:129], v6 offset:0
    ds_read_b64_tr_b16 v[130:131], v6 offset:2048
    ds_read_b64_tr_b16 v[132:133], v7 offset:0
    ds_read_b64_tr_b16 v[134:135], v7 offset:2048
    ds_read_b64_tr_b16 v[136:137], v8 offset:0
    ds_read_b64_tr_b16 v[138:139], v8 offset:2048
    ds_read_b64_tr_b16 v[140:141], v9 offset:0
    ds_read_b64_tr_b16 v[142:143], v9 offset:2048
    s_waitcnt lgkmcnt(8)
    v_lshlrev_b32 v16, 16, v48
    v_and_b32 v17, s46, v48
    v_fma_f32 v16, v16, v160, v168
    v_fma_f32 v17, v17, v161, v169
    v_cvt_pk_bf16_f32 v88, v16, v17
    v_lshlrev_b32 v18, 16, v49
    v_and_b32 v19, s46, v49
    v_fma_f32 v18, v18, v162, v170
    v_fma_f32 v19, v19, v163, v171
    v_cvt_pk_bf16_f32 v89, v18, v19
    v_lshlrev_b32 v16, 16, v50
    v_and_b32 v17, s46, v50
    v_fma_f32 v16, v16, v164, v172
    v_fma_f32 v17, v17, v165, v173
    v_cvt_pk_bf16_f32 v90, v16, v17
    v_lshlrev_b32 v18, 16, v51
    v_and_b32 v19, s46, v51
    v_fma_f32 v18, v18, v166, v174
    v_fma_f32 v19, v19, v167, v175
    v_cvt_pk_bf16_f32 v91, v18, v19
    buffer_load_dwordx4 v[48:51], v3, s[28:31], s41 offen
    v_lshlrev_b32 v16, 16, v52
    v_and_b32 v17, s46, v52
    v_fma_f32 v16, v16, v160, v168
    v_fma_f32 v17, v17, v161, v169
    v_cvt_pk_bf16_f32 v92, v16, v17
    v_lshlrev_b32 v18, 16, v53
    v_and_b32 v19, s46, v53
    v_fma_f32 v18, v18, v162, v170
    v_fma_f32 v19, v19, v163, v171
    v_cvt_pk_bf16_f32 v93, v18, v19
    v_lshlrev_b32 v16, 16, v54
    s_waitcnt lgkmcnt(0)
    v_and_b32 v17, s46, v54
    v_fma_f32 v16, v16, v164, v172
    v_fma_f32 v17, v17, v165, v173
    v_cvt_pk_bf16_f32 v94, v16, v17
    v_lshlrev_b32 v18, 16, v55
    v_and_b32 v19, s46, v55
    v_fma_f32 v18, v18, v166, v174
    v_fma_f32 v19, v19, v167, v175
    v_cvt_pk_bf16_f32 v95, v18, v19
    buffer_load_dwordx4 v[52:55], v20, s[28:31], s41 offen
    v_lshlrev_b32 v16, 16, v56
    s_mov_b32 m0, s64
    s_nop 0
    buffer_load_dwordx4 v44, s[20:23], s40 offen offset:0 lds
    v_and_b32 v17, s46, v56
    v_fma_f32 v16, v16, v160, v168
    v_fma_f32 v17, v17, v161, v169
    v_cvt_pk_bf16_f32 v96, v16, v17
    v_lshlrev_b32 v18, 16, v57
    v_and_b32 v19, s46, v57
    v_fma_f32 v18, v18, v162, v170
    v_fma_f32 v19, v19, v163, v171
    v_cvt_pk_bf16_f32 v97, v18, v19
    v_lshlrev_b32 v16, 16, v58
    v_and_b32 v17, s46, v58
    v_fma_f32 v16, v16, v164, v172
    v_fma_f32 v17, v17, v165, v173
    v_cvt_pk_bf16_f32 v98, v16, v17
    v_lshlrev_b32 v18, 16, v59
    buffer_load_dwordx4 v45, s[20:23], s40 offen offset:1024 lds
    v_and_b32 v19, s46, v59
    v_fma_f32 v18, v18, v166, v174
    v_fma_f32 v19, v19, v167, v175
    v_cvt_pk_bf16_f32 v99, v18, v19
    buffer_load_dwordx4 v[56:59], v21, s[28:31], s41 offen
    v_lshlrev_b32 v16, 16, v60
    v_and_b32 v17, s46, v60
    v_fma_f32 v16, v16, v160, v168
    v_fma_f32 v17, v17, v161, v169
    v_cvt_pk_bf16_f32 v100, v16, v17
    v_lshlrev_b32 v18, 16, v61
    v_and_b32 v19, s46, v61
    v_fma_f32 v18, v18, v162, v170
    v_fma_f32 v19, v19, v163, v171
    v_cvt_pk_bf16_f32 v101, v18, v19
    v_lshlrev_b32 v16, 16, v62
    buffer_load_dwordx4 v46, s[20:23], s40 offen offset:2048 lds
    v_and_b32 v17, s46, v62
    v_fma_f32 v16, v16, v164, v172
    v_fma_f32 v17, v17, v165, v173
    v_cvt_pk_bf16_f32 v102, v16, v17
    v_lshlrev_b32 v18, 16, v63
    v_and_b32 v19, s46, v63
    v_fma_f32 v18, v18, v166, v174
    v_fma_f32 v19, v19, v167, v175
    v_cvt_pk_bf16_f32 v103, v18, v19
    buffer_load_dwordx4 v[60:63], v22, s[28:31], s41 offen
    v_lshlrev_b32 v16, 16, v64
    v_and_b32 v17, s46, v64
    v_fma_f32 v16, v16, v160, v168
    v_fma_f32 v17, v17, v161, v169
    v_cvt_pk_bf16_f32 v104, v16, v17
    v_lshlrev_b32 v18, 16, v65
    buffer_load_dwordx4 v47, s[20:23], s40 offen offset:3072 lds
    s_add_u32 s40, s40, 110592
    v_and_b32 v19, s46, v65
    v_fma_f32 v18, v18, v162, v170
    v_fma_f32 v19, v19, v163, v171
    v_cvt_pk_bf16_f32 v105, v18, v19
    v_lshlrev_b32 v16, 16, v66
    v_and_b32 v17, s46, v66
    v_fma_f32 v16, v16, v164, v172
    v_fma_f32 v17, v17, v165, v173
    v_cvt_pk_bf16_f32 v106, v16, v17
    v_lshlrev_b32 v18, 16, v67
    v_and_b32 v19, s46, v67
    v_fma_f32 v18, v18, v166, v174
    v_fma_f32 v19, v19, v167, v175
    v_cvt_pk_bf16_f32 v107, v18, v19
    buffer_load_dwordx4 v[64:67], v23, s[28:31], s41 offen
    s_add_u32 s41, s41, 1024
    s_waitcnt vmcnt(9) lgkmcnt(0)
    ds_read_b128 v[160:163], v15
    ds_read_b128 v[164:167], v15 offset:64
    ds_read_b128 v[168:171], v15 offset:1024
    ds_read_b128 v[172:175], v15 offset:1088
    v_add_u32 v15, 128, v15
    ds_read_b64_tr_b16 v[144:145], v6 offset:4096
    ds_read_b64_tr_b16 v[146:147], v6 offset:6144
    ds_read_b64_tr_b16 v[148:149], v7 offset:4096
    ds_read_b64_tr_b16 v[150:151], v7 offset:6144
    ds_read_b64_tr_b16 v[152:153], v8 offset:4096
    ds_read_b64_tr_b16 v[154:155], v8 offset:6144
    ds_read_b64_tr_b16 v[156:157], v9 offset:4096
    ds_read_b64_tr_b16 v[158:159], v9 offset:6144
    v_mfma_f32_16x16x32_bf16 a[0:3], v[128:131], v[88:91], a[0:3]
    v_mfma_f32_16x16x32_bf16 a[4:7], v[132:135], v[88:91], a[4:7]
    v_mfma_f32_16x16x32_bf16 a[8:11], v[136:139], v[88:91], a[8:11]
    s_waitcnt lgkmcnt(8)
    v_lshlrev_b32 v16, 16, v68
    v_and_b32 v17, s46, v68
    v_fma_f32 v16, v16, v160, v168
    v_fma_f32 v17, v17, v161, v169
    v_cvt_pk_bf16_f32 v108, v16, v17
    v_lshlrev_b32 v18, 16, v69
    v_mfma_f32_16x16x32_bf16 a[12:15], v[140:143], v[88:91], a[12:15]
    v_and_b32 v19, s46, v69
    v_fma_f32 v18, v18, v162, v170
    v_fma_f32 v19, v19, v163, v171
    v_cvt_pk_bf16_f32 v109, v18, v19
    v_lshlrev_b32 v16, 16, v70
    v_and_b32 v17, s46, v70
    v_mfma_f32_16x16x32_bf16 a[16:19], v[128:131], v[92:95], a[16:19]
    v_fma_f32 v16, v16, v164, v172
    v_fma_f32 v17, v17, v165, v173
    v_cvt_pk_bf16_f32 v110, v16, v17
    v_lshlrev_b32 v18, 16, v71
    v_and_b32 v19, s46, v71
    v_fma_f32 v18, v18, v166, v174
    v_mfma_f32_16x16x32_bf16 a[20:23], v[132:135], v[92:95], a[20:23]
    v_fma_f32 v19, v19, v167, v175
    v_cvt_pk_bf16_f32 v111, v18, v19
    buffer_load_dwordx4 v[68:71], v3, s[28:31], s41 offen
    v_lshlrev_b32 v16, 16, v72
    v_and_b32 v17, s46, v72
    v_fma_f32 v16, v16, v160, v168
    v_fma_f32 v17, v17, v161, v169
    v_mfma_f32_16x16x32_bf16 a[24:27], v[136:139], v[92:95], a[24:27]
    v_cvt_pk_bf16_f32 v112, v16, v17
    v_lshlrev_b32 v18, 16, v73
    v_and_b32 v19, s46, v73
    v_fma_f32 v18, v18, v162, v170
    v_fma_f32 v19, v19, v163, v171
    v_cvt_pk_bf16_f32 v113, v18, v19
    v_mfma_f32_16x16x32_bf16 a[28:31], v[140:143], v[92:95], a[28:31]
    v_lshlrev_b32 v16, 16, v74
    s_waitcnt lgkmcnt(0)
    v_and_b32 v17, s46, v74
    v_fma_f32 v16, v16, v164, v172
    v_fma_f32 v17, v17, v165, v173
    v_cvt_pk_bf16_f32 v114, v16, v17
    v_lshlrev_b32 v18, 16, v75
    v_mfma_f32_16x16x32_bf16 a[32:35], v[128:131], v[96:99], a[32:35]
    v_and_b32 v19, s46, v75
    v_fma_f32 v18, v18, v166, v174
    v_fma_f32 v19, v19, v167, v175
    v_cvt_pk_bf16_f32 v115, v18, v19
    buffer_load_dwordx4 v[72:75], v20, s[28:31], s41 offen
    v_lshlrev_b32 v16, 16, v76
    s_mov_b32 m0, s65
    s_nop 0
    buffer_load_dwordx4 v44, s[20:23], s40 offen offset:0 lds
    v_and_b32 v17, s46, v76
    v_mfma_f32_16x16x32_bf16 a[36:39], v[132:135], v[96:99], a[36:39]
    v_fma_f32 v16, v16, v160, v168
    v_fma_f32 v17, v17, v161, v169
    v_cvt_pk_bf16_f32 v116, v16, v17
    v_lshlrev_b32 v18, 16, v77
    v_and_b32 v19, s46, v77
    v_fma_f32 v18, v18, v162, v170
    v_mfma_f32_16x16x32_bf16 a[40:43], v[136:139], v[96:99], a[40:43]
    v_fma_f32 v19, v19, v163, v171
    v_cvt_pk_bf16_f32 v117, v18, v19
    v_lshlrev_b32 v16, 16, v78
    v_and_b32 v17, s46, v78
    v_fma_f32 v16, v16, v164, v172
    v_fma_f32 v17, v17, v165, v173
    v_mfma_f32_16x16x32_bf16 a[44:47], v[140:143], v[96:99], a[44:47]
    v_cvt_pk_bf16_f32 v118, v16, v17
    v_lshlrev_b32 v18, 16, v79
    buffer_load_dwordx4 v45, s[20:23], s40 offen offset:1024 lds
    v_and_b32 v19, s46, v79
    v_fma_f32 v18, v18, v166, v174
    v_fma_f32 v19, v19, v167, v175
    v_cvt_pk_bf16_f32 v119, v18, v19
    v_mfma_f32_16x16x32_bf16 a[48:51], v[128:131], v[100:103], a[48:51]
    buffer_load_dwordx4 v[76:79], v21, s[28:31], s41 offen
    v_lshlrev_b32 v16, 16, v80
    v_and_b32 v17, s46, v80
    v_fma_f32 v16, v16, v160, v168
    v_fma_f32 v17, v17, v161, v169
    v_cvt_pk_bf16_f32 v120, v16, v17
    v_lshlrev_b32 v18, 16, v81
    v_mfma_f32_16x16x32_bf16 a[52:55], v[132:135], v[100:103], a[52:55]
    v_and_b32 v19, s46, v81
    v_fma_f32 v18, v18, v162, v170
    v_fma_f32 v19, v19, v163, v171
    v_cvt_pk_bf16_f32 v121, v18, v19
    v_lshlrev_b32 v16, 16, v82
    buffer_load_dwordx4 v46, s[20:23], s40 offen offset:2048 lds
    v_and_b32 v17, s46, v82
    v_mfma_f32_16x16x32_bf16 a[56:59], v[136:139], v[100:103], a[56:59]
    v_fma_f32 v16, v16, v164, v172
    v_fma_f32 v17, v17, v165, v173
    v_cvt_pk_bf16_f32 v122, v16, v17
    v_lshlrev_b32 v18, 16, v83
    v_and_b32 v19, s46, v83
    v_fma_f32 v18, v18, v166, v174
    v_mfma_f32_16x16x32_bf16 a[60:63], v[140:143], v[100:103], a[60:63]
    v_fma_f32 v19, v19, v167, v175
    v_cvt_pk_bf16_f32 v123, v18, v19
    buffer_load_dwordx4 v[80:83], v22, s[28:31], s41 offen
    v_lshlrev_b32 v16, 16, v84
    v_and_b32 v17, s46, v84
    v_fma_f32 v16, v16, v160, v168
    v_fma_f32 v17, v17, v161, v169
    v_mfma_f32_16x16x32_bf16 a[64:67], v[128:131], v[104:107], a[64:67]
    v_cvt_pk_bf16_f32 v124, v16, v17
    v_lshlrev_b32 v18, 16, v85
    buffer_load_dwordx4 v47, s[20:23], s40 offen offset:3072 lds
    s_add_u32 s40, s40, 110592
    v_and_b32 v19, s46, v85
    v_fma_f32 v18, v18, v162, v170
    v_fma_f32 v19, v19, v163, v171
    v_cvt_pk_bf16_f32 v125, v18, v19
    v_mfma_f32_16x16x32_bf16 a[68:71], v[132:135], v[104:107], a[68:71]
    v_lshlrev_b32 v16, 16, v86
    v_and_b32 v17, s46, v86
    v_fma_f32 v16, v16, v164, v172
    v_fma_f32 v17, v17, v165, v173
    v_cvt_pk_bf16_f32 v126, v16, v17
    v_lshlrev_b32 v18, 16, v87
    v_mfma_f32_16x16x32_bf16 a[72:75], v[136:139], v[104:107], a[72:75]
    v_and_b32 v19, s46, v87
    v_fma_f32 v18, v18, v166, v174
    v_fma_f32 v19, v19, v167, v175
    v_cvt_pk_bf16_f32 v127, v18, v19
    buffer_load_dwordx4 v[84:87], v23, s[28:31], s41 offen
    s_add_u32 s41, s41, 1024
    v_mfma_f32_16x16x32_bf16 a[76:79], v[140:143], v[104:107], a[76:79]
    s_waitcnt vmcnt(9) lgkmcnt(0)
    ds_read_b128 v[160:163], v15
    ds_read_b128 v[164:167], v15 offset:64
    ds_read_b128 v[168:171], v15 offset:1024
    ds_read_b128 v[172:175], v15 offset:1088
    v_add_u32 v15, 128, v15
    ds_read_b64_tr_b16 v[128:129], v6 offset:0
    ds_read_b64_tr_b16 v[130:131], v6 offset:2048
    ds_read_b64_tr_b16 v[132:133], v7 offset:0
    ds_read_b64_tr_b16 v[134:135], v7 offset:2048
    ds_read_b64_tr_b16 v[136:137], v8 offset:0
    ds_read_b64_tr_b16 v[138:139], v8 offset:2048
    ds_read_b64_tr_b16 v[140:141], v9 offset:0
    ds_read_b64_tr_b16 v[142:143], v9 offset:2048
    v_mfma_f32_16x16x32_bf16 a[0:3], v[144:147], v[108:111], a[0:3]
    v_mfma_f32_16x16x32_bf16 a[4:7], v[148:151], v[108:111], a[4:7]
    v_mfma_f32_16x16x32_bf16 a[8:11], v[152:155], v[108:111], a[8:11]
    s_waitcnt lgkmcnt(8)
    v_lshlrev_b32 v16, 16, v48
    v_and_b32 v17, s46, v48
    v_fma_f32 v16, v16, v160, v168
    v_fma_f32 v17, v17, v161, v169
    v_cvt_pk_bf16_f32 v88, v16, v17
    v_lshlrev_b32 v18, 16, v49
    v_mfma_f32_16x16x32_bf16 a[12:15], v[156:159], v[108:111], a[12:15]
    v_and_b32 v19, s46, v49
    v_fma_f32 v18, v18, v162, v170
    v_fma_f32 v19, v19, v163, v171
    v_cvt_pk_bf16_f32 v89, v18, v19
    v_lshlrev_b32 v16, 16, v50
    v_and_b32 v17, s46, v50
    v_mfma_f32_16x16x32_bf16 a[16:19], v[144:147], v[112:115], a[16:19]
    v_fma_f32 v16, v16, v164, v172
    v_fma_f32 v17, v17, v165, v173
    v_cvt_pk_bf16_f32 v90, v16, v17
    v_lshlrev_b32 v18, 16, v51
    v_and_b32 v19, s46, v51
    v_fma_f32 v18, v18, v166, v174
    v_mfma_f32_16x16x32_bf16 a[20:23], v[148:151], v[112:115], a[20:23]
    v_fma_f32 v19, v19, v167, v175
    v_cvt_pk_bf16_f32 v91, v18, v19
    buffer_load_dwordx4 v[48:51], v3, s[28:31], s41 offen
    v_lshlrev_b32 v16, 16, v52
    v_and_b32 v17, s46, v52
    v_fma_f32 v16, v16, v160, v168
    v_fma_f32 v17, v17, v161, v169
    v_mfma_f32_16x16x32_bf16 a[24:27], v[152:155], v[112:115], a[24:27]
    v_cvt_pk_bf16_f32 v92, v16, v17
    v_lshlrev_b32 v18, 16, v53
    v_and_b32 v19, s46, v53
    v_fma_f32 v18, v18, v162, v170
    v_fma_f32 v19, v19, v163, v171
    v_cvt_pk_bf16_f32 v93, v18, v19
    v_mfma_f32_16x16x32_bf16 a[28:31], v[156:159], v[112:115], a[28:31]
    v_lshlrev_b32 v16, 16, v54
    s_waitcnt lgkmcnt(0)
    v_and_b32 v17, s46, v54
    v_fma_f32 v16, v16, v164, v172
    v_fma_f32 v17, v17, v165, v173
    v_cvt_pk_bf16_f32 v94, v16, v17
    v_lshlrev_b32 v18, 16, v55
    v_mfma_f32_16x16x32_bf16 a[32:35], v[144:147], v[116:119], a[32:35]
    v_and_b32 v19, s46, v55
    v_fma_f32 v18, v18, v166, v174
    v_fma_f32 v19, v19, v167, v175
    v_cvt_pk_bf16_f32 v95, v18, v19
    buffer_load_dwordx4 v[52:55], v20, s[28:31], s41 offen
    v_lshlrev_b32 v16, 16, v56
    s_mov_b32 m0, s64
    s_nop 0
    buffer_load_dwordx4 v44, s[20:23], s40 offen offset:0 lds
    v_and_b32 v17, s46, v56
    v_mfma_f32_16x16x32_bf16 a[36:39], v[148:151], v[116:119], a[36:39]
    v_fma_f32 v16, v16, v160, v168
    v_fma_f32 v17, v17, v161, v169
    v_cvt_pk_bf16_f32 v96, v16, v17
    v_lshlrev_b32 v18, 16, v57
    v_and_b32 v19, s46, v57
    v_fma_f32 v18, v18, v162, v170
    v_mfma_f32_16x16x32_bf16 a[40:43], v[152:155], v[116:119], a[40:43]
    v_fma_f32 v19, v19, v163, v171
    v_cvt_pk_bf16_f32 v97, v18, v19
    v_lshlrev_b32 v16, 16, v58
    v_and_b32 v17, s46, v58
    v_fma_f32 v16, v16, v164, v172
    v_fma_f32 v17, v17, v165, v173
    v_mfma_f32_16x16x32_bf16 a[44:47], v[156:159], v[116:119], a[44:47]
    v_cvt_pk_bf16_f32 v98, v16, v17
    v_lshlrev_b32 v18, 16, v59
    buffer_load_dwordx4 v45, s[20:23], s40 offen offset:1024 lds
    v_and_b32 v19, s46, v59
    v_fma_f32 v18, v18, v166, v174
    v_fma_f32 v19, v19, v167, v175
    v_cvt_pk_bf16_f32 v99, v18, v19
    v_mfma_f32_16x16x32_bf16 a[48:51], v[144:147], v[120:123], a[48:51]
    buffer_load_dwordx4 v[56:59], v21, s[28:31], s41 offen
    v_lshlrev_b32 v16, 16, v60
    v_and_b32 v17, s46, v60
    v_fma_f32 v16, v16, v160, v168
    v_fma_f32 v17, v17, v161, v169
    v_cvt_pk_bf16_f32 v100, v16, v17
    v_lshlrev_b32 v18, 16, v61
    v_mfma_f32_16x16x32_bf16 a[52:55], v[148:151], v[120:123], a[52:55]
    v_and_b32 v19, s46, v61
    v_fma_f32 v18, v18, v162, v170
    v_fma_f32 v19, v19, v163, v171
    v_cvt_pk_bf16_f32 v101, v18, v19
    v_lshlrev_b32 v16, 16, v62
    buffer_load_dwordx4 v46, s[20:23], s40 offen offset:2048 lds
    v_and_b32 v17, s46, v62
    v_mfma_f32_16x16x32_bf16 a[56:59], v[152:155], v[120:123], a[56:59]
    v_fma_f32 v16, v16, v164, v172
    v_fma_f32 v17, v17, v165, v173
    v_cvt_pk_bf16_f32 v102, v16, v17
    v_lshlrev_b32 v18, 16, v63
    v_and_b32 v19, s46, v63
    v_fma_f32 v18, v18, v166, v174
    v_mfma_f32_16x16x32_bf16 a[60:63], v[156:159], v[120:123], a[60:63]
    v_fma_f32 v19, v19, v167, v175
    v_cvt_pk_bf16_f32 v103, v18, v19
    buffer_load_dwordx4 v[60:63], v22, s[28:31], s41 offen
    v_lshlrev_b32 v16, 16, v64
    v_and_b32 v17, s46, v64
    v_fma_f32 v16, v16, v160, v168
    v_fma_f32 v17, v17, v161, v169
    v_mfma_f32_16x16x32_bf16 a[64:67], v[144:147], v[124:127], a[64:67]
    v_cvt_pk_bf16_f32 v104, v16, v17
    v_lshlrev_b32 v18, 16, v65
    buffer_load_dwordx4 v47, s[20:23], s40 offen offset:3072 lds
    s_add_u32 s40, s40, 110592
    v_and_b32 v19, s46, v65
    v_fma_f32 v18, v18, v162, v170
    v_fma_f32 v19, v19, v163, v171
    v_cvt_pk_bf16_f32 v105, v18, v19
    v_mfma_f32_16x16x32_bf16 a[68:71], v[148:151], v[124:127], a[68:71]
    v_lshlrev_b32 v16, 16, v66
    v_and_b32 v17, s46, v66
    v_fma_f32 v16, v16, v164, v172
    v_fma_f32 v17, v17, v165, v173
    v_cvt_pk_bf16_f32 v106, v16, v17
    v_lshlrev_b32 v18, 16, v67
    v_mfma_f32_16x16x32_bf16 a[72:75], v[152:155], v[124:127], a[72:75]
    v_and_b32 v19, s46, v67
    v_fma_f32 v18, v18, v166, v174
    v_fma_f32 v19, v19, v167, v175
    v_cvt_pk_bf16_f32 v107, v18, v19
    buffer_load_dwordx4 v[64:67], v23, s[28:31], s41 offen
    s_add_u32 s41, s41, 1024
    v_mfma_f32_16x16x32_bf16 a[76:79], v[156:159], v[124:127], a[76:79]
    s_waitcnt vmcnt(9) lgkmcnt(0)
    ds_read_b128 v[160:163], v15
    ds_read_b128 v[164:167], v15 offset:64
    ds_read_b128 v[168:171], v15 offset:1024
    ds_read_b128 v[172:175], v15 offset:1088
    v_add_u32 v15, 128, v15
    ds_read_b64_tr_b16 v[144:145], v6 offset:4096
    ds_read_b64_tr_b16 v[146:147], v6 offset:6144
    ds_read_b64_tr_b16 v[148:149], v7 offset:4096
    ds_read_b64_tr_b16 v[150:151], v7 offset:6144
    ds_read_b64_tr_b16 v[152:153], v8 offset:4096
    ds_read_b64_tr_b16 v[154:155], v8 offset:6144
    ds_read_b64_tr_b16 v[156:157], v9 offset:4096
    ds_read_b64_tr_b16 v[158:159], v9 offset:6144
    v_mfma_f32_16x16x32_bf16 a[0:3], v[128:131], v[88:91], a[0:3]
    v_mfma_f32_16x16x32_bf16 a[4:7], v[132:135], v[88:91], a[4:7]
    v_mfma_f32_16x16x32_bf16 a[8:11], v[136:139], v[88:91], a[8:11]
    s_waitcnt lgkmcnt(8)
    v_lshlrev_b32 v16, 16, v68
    v_and_b32 v17, s46, v68
    v_fma_f32 v16, v16, v160, v168
    v_fma_f32 v17, v17, v161, v169
    v_cvt_pk_bf16_f32 v108, v16, v17
    v_lshlrev_b32 v18, 16, v69
    v_mfma_f32_16x16x32_bf16 a[12:15], v[140:143], v[88:91], a[12:15]
    v_and_b32 v19, s46, v69
    v_fma_f32 v18, v18, v162, v170
    v_fma_f32 v19, v19, v163, v171
    v_cvt_pk_bf16_f32 v109, v18, v19
    v_lshlrev_b32 v16, 16, v70
    v_and_b32 v17, s46, v70
    v_mfma_f32_16x16x32_bf16 a[16:19], v[128:131], v[92:95], a[16:19]
    v_fma_f32 v16, v16, v164, v172
    v_fma_f32 v17, v17, v165, v173
    v_cvt_pk_bf16_f32 v110, v16, v17
    v_lshlrev_b32 v18, 16, v71
    v_and_b32 v19, s46, v71
    v_fma_f32 v18, v18, v166, v174
    v_mfma_f32_16x16x32_bf16 a[20:23], v[132:135], v[92:95], a[20:23]
    v_fma_f32 v19, v19, v167, v175
    v_cvt_pk_bf16_f32 v111, v18, v19
    buffer_load_dwordx4 v[68:71], v3, s[28:31], s41 offen
    v_lshlrev_b32 v16, 16, v72
    v_and_b32 v17, s46, v72
    v_fma_f32 v16, v16, v160, v168
    v_fma_f32 v17, v17, v161, v169
    v_mfma_f32_16x16x32_bf16 a[24:27], v[136:139], v[92:95], a[24:27]
    v_cvt_pk_bf16_f32 v112, v16, v17
    v_lshlrev_b32 v18, 16, v73
    v_and_b32 v19, s46, v73
    v_fma_f32 v18, v18, v162, v170
    v_fma_f32 v19, v19, v163, v171
    v_cvt_pk_bf16_f32 v113, v18, v19
    v_mfma_f32_16x16x32_bf16 a[28:31], v[140:143], v[92:95], a[28:31]
    v_lshlrev_b32 v16, 16, v74
    s_waitcnt lgkmcnt(0)
    v_and_b32 v17, s46, v74
    v_fma_f32 v16, v16, v164, v172
    v_fma_f32 v17, v17, v165, v173
    v_cvt_pk_bf16_f32 v114, v16, v17
    v_lshlrev_b32 v18, 16, v75
    v_mfma_f32_16x16x32_bf16 a[32:35], v[128:131], v[96:99], a[32:35]
    v_and_b32 v19, s46, v75
    v_fma_f32 v18, v18, v166, v174
    v_fma_f32 v19, v19, v167, v175
    v_cvt_pk_bf16_f32 v115, v18, v19
    buffer_load_dwordx4 v[72:75], v20, s[28:31], s41 offen
    v_lshlrev_b32 v16, 16, v76
    s_mov_b32 m0, s65
    s_nop 0
    buffer_load_dwordx4 v44, s[20:23], s40 offen offset:0 lds
    v_and_b32 v17, s46, v76
    v_mfma_f32_16x16x32_bf16 a[36:39], v[132:135], v[96:99], a[36:39]
    v_fma_f32 v16, v16, v160, v168
    v_fma_f32 v17, v17, v161, v169
    v_cvt_pk_bf16_f32 v116, v16, v17
    v_lshlrev_b32 v18, 16, v77
    v_and_b32 v19, s46, v77
    v_fma_f32 v18, v18, v162, v170
    v_mfma_f32_16x16x32_bf16 a[40:43], v[136:139], v[96:99], a[40:43]
    v_fma_f32 v19, v19, v163, v171
    v_cvt_pk_bf16_f32 v117, v18, v19
    v_lshlrev_b32 v16, 16, v78
    v_and_b32 v17, s46, v78
    v_fma_f32 v16, v16, v164, v172
    v_fma_f32 v17, v17, v165, v173
    v_mfma_f32_16x16x32_bf16 a[44:47], v[140:143], v[96:99], a[44:47]
    v_cvt_pk_bf16_f32 v118, v16, v17
    v_lshlrev_b32 v18, 16, v79
    buffer_load_dwordx4 v45, s[20:23], s40 offen offset:1024 lds
    v_and_b32 v19, s46, v79
    v_fma_f32 v18, v18, v166, v174
    v_fma_f32 v19, v19, v167, v175
    v_cvt_pk_bf16_f32 v119, v18, v19
    v_mfma_f32_16x16x32_bf16 a[48:51], v[128:131], v[100:103], a[48:51]
    buffer_load_dwordx4 v[76:79], v21, s[28:31], s41 offen
    v_lshlrev_b32 v16, 16, v80
    v_and_b32 v17, s46, v80
    v_fma_f32 v16, v16, v160, v168
    v_fma_f32 v17, v17, v161, v169
    v_cvt_pk_bf16_f32 v120, v16, v17
    v_lshlrev_b32 v18, 16, v81
    v_mfma_f32_16x16x32_bf16 a[52:55], v[132:135], v[100:103], a[52:55]
    v_and_b32 v19, s46, v81
    v_fma_f32 v18, v18, v162, v170
    v_fma_f32 v19, v19, v163, v171
    v_cvt_pk_bf16_f32 v121, v18, v19
    v_lshlrev_b32 v16, 16, v82
    buffer_load_dwordx4 v46, s[20:23], s40 offen offset:2048 lds
    v_and_b32 v17, s46, v82
    v_mfma_f32_16x16x32_bf16 a[56:59], v[136:139], v[100:103], a[56:59]
    v_fma_f32 v16, v16, v164, v172
    v_fma_f32 v17, v17, v165, v173
    v_cvt_pk_bf16_f32 v122, v16, v17
    v_lshlrev_b32 v18, 16, v83
    v_and_b32 v19, s46, v83
    v_fma_f32 v18, v18, v166, v174
    v_mfma_f32_16x16x32_bf16 a[60:63], v[140:143], v[100:103], a[60:63]
    v_fma_f32 v19, v19, v167, v175
    v_cvt_pk_bf16_f32 v123, v18, v19
    buffer_load_dwordx4 v[80:83], v22, s[28:31], s41 offen
    v_lshlrev_b32 v16, 16, v84
    v_and_b32 v17, s46, v84
    v_fma_f32 v16, v16, v160, v168
    v_fma_f32 v17, v17, v161, v169
    v_mfma_f32_16x16x32_bf16 a[64:67], v[128:131], v[104:107], a[64:67]
    v_cvt_pk_bf16_f32 v124, v16, v17
    v_lshlrev_b32 v18, 16, v85
    buffer_load_dwordx4 v47, s[20:23], s40 offen offset:3072 lds
    s_add_u32 s40, s40, 110592
    v_and_b32 v19, s46, v85
    v_fma_f32 v18, v18, v162, v170
    v_fma_f32 v19, v19, v163, v171
    v_cvt_pk_bf16_f32 v125, v18, v19
    v_mfma_f32_16x16x32_bf16 a[68:71], v[132:135], v[104:107], a[68:71]
    v_lshlrev_b32 v16, 16, v86
    v_and_b32 v17, s46, v86
    v_fma_f32 v16, v16, v164, v172
    v_fma_f32 v17, v17, v165, v173
    v_cvt_pk_bf16_f32 v126, v16, v17
    v_lshlrev_b32 v18, 16, v87
    v_mfma_f32_16x16x32_bf16 a[72:75], v[136:139], v[104:107], a[72:75]
    v_and_b32 v19, s46, v87
    v_fma_f32 v18, v18, v166, v174
    v_fma_f32 v19, v19, v167, v175
    v_cvt_pk_bf16_f32 v127, v18, v19
    buffer_load_dwordx4 v[84:87], v23, s[28:31], s41 offen
    s_add_u32 s41, s41, 1024
    v_mfma_f32_16x16x32_bf16 a[76:79], v[140:143], v[104:107], a[76:79]
    s_waitcnt vmcnt(9) lgkmcnt(0)
    ds_read_b128 v[160:163], v15
    ds_read_b128 v[164:167], v15 offset:64
    ds_read_b128 v[168:171], v15 offset:1024
    ds_read_b128 v[172:175], v15 offset:1088
    v_add_u32 v15, 128, v15
    ds_read_b64_tr_b16 v[128:129], v6 offset:0
    ds_read_b64_tr_b16 v[130:131], v6 offset:2048
    ds_read_b64_tr_b16 v[132:133], v7 offset:0
    ds_read_b64_tr_b16 v[134:135], v7 offset:2048
    ds_read_b64_tr_b16 v[136:137], v8 offset:0
    ds_read_b64_tr_b16 v[138:139], v8 offset:2048
    ds_read_b64_tr_b16 v[140:141], v9 offset:0
    ds_read_b64_tr_b16 v[142:143], v9 offset:2048
    v_mfma_f32_16x16x32_bf16 a[0:3], v[144:147], v[108:111], a[0:3]
    v_mfma_f32_16x16x32_bf16 a[4:7], v[148:151], v[108:111], a[4:7]
    v_mfma_f32_16x16x32_bf16 a[8:11], v[152:155], v[108:111], a[8:11]
    s_waitcnt lgkmcnt(8)
    v_lshlrev_b32 v16, 16, v48
    v_and_b32 v17, s46, v48
    v_fma_f32 v16, v16, v160, v168
    v_fma_f32 v17, v17, v161, v169
    v_cvt_pk_bf16_f32 v88, v16, v17
    v_lshlrev_b32 v18, 16, v49
    v_mfma_f32_16x16x32_bf16 a[12:15], v[156:159], v[108:111], a[12:15]
    v_and_b32 v19, s46, v49
    v_fma_f32 v18, v18, v162, v170
    v_fma_f32 v19, v19, v163, v171
    v_cvt_pk_bf16_f32 v89, v18, v19
    v_lshlrev_b32 v16, 16, v50
    v_and_b32 v17, s46, v50
    v_mfma_f32_16x16x32_bf16 a[16:19], v[144:147], v[112:115], a[16:19]
    v_fma_f32 v16, v16, v164, v172
    v_fma_f32 v17, v17, v165, v173
    v_cvt_pk_bf16_f32 v90, v16, v17
    v_lshlrev_b32 v18, 16, v51
    v_and_b32 v19, s46, v51
    v_fma_f32 v18, v18, v166, v174
    v_mfma_f32_16x16x32_bf16 a[20:23], v[148:151], v[112:115], a[20:23]
    v_fma_f32 v19, v19, v167, v175
    v_cvt_pk_bf16_f32 v91, v18, v19
    buffer_load_dwordx4 v[48:51], v3, s[28:31], s41 offen
    v_lshlrev_b32 v16, 16, v52
    v_and_b32 v17, s46, v52
    v_fma_f32 v16, v16, v160, v168
    v_fma_f32 v17, v17, v161, v169
    v_mfma_f32_16x16x32_bf16 a[24:27], v[152:155], v[112:115], a[24:27]
    v_cvt_pk_bf16_f32 v92, v16, v17
    v_lshlrev_b32 v18, 16, v53
    v_and_b32 v19, s46, v53
    v_fma_f32 v18, v18, v162, v170
    v_fma_f32 v19, v19, v163, v171
    v_cvt_pk_bf16_f32 v93, v18, v19
    v_mfma_f32_16x16x32_bf16 a[28:31], v[156:159], v[112:115], a[28:31]
    v_lshlrev_b32 v16, 16, v54
    s_waitcnt lgkmcnt(0)
    v_and_b32 v17, s46, v54
    v_fma_f32 v16, v16, v164, v172
    v_fma_f32 v17, v17, v165, v173
    v_cvt_pk_bf16_f32 v94, v16, v17
    v_lshlrev_b32 v18, 16, v55
    v_mfma_f32_16x16x32_bf16 a[32:35], v[144:147], v[116:119], a[32:35]
    v_and_b32 v19, s46, v55
    v_fma_f32 v18, v18, v166, v174
    v_fma_f32 v19, v19, v167, v175
    v_cvt_pk_bf16_f32 v95, v18, v19
    buffer_load_dwordx4 v[52:55], v20, s[28:31], s41 offen
    v_lshlrev_b32 v16, 16, v56
    s_mov_b32 m0, s64
    s_nop 0
    buffer_load_dwordx4 v44, s[20:23], s40 offen offset:0 lds
    v_and_b32 v17, s46, v56
    v_mfma_f32_16x16x32_bf16 a[36:39], v[148:151], v[116:119], a[36:39]
    v_fma_f32 v16, v16, v160, v168
    v_fma_f32 v17, v17, v161, v169
    v_cvt_pk_bf16_f32 v96, v16, v17
    v_lshlrev_b32 v18, 16, v57
    v_and_b32 v19, s46, v57
    v_fma_f32 v18, v18, v162, v170
    v_mfma_f32_16x16x32_bf16 a[40:43], v[152:155], v[116:119], a[40:43]
    v_fma_f32 v19, v19, v163, v171
    v_cvt_pk_bf16_f32 v97, v18, v19
    v_lshlrev_b32 v16, 16, v58
    v_and_b32 v17, s46, v58
    v_fma_f32 v16, v16, v164, v172
    v_fma_f32 v17, v17, v165, v173
    v_mfma_f32_16x16x32_bf16 a[44:47], v[156:159], v[116:119], a[44:47]
    v_cvt_pk_bf16_f32 v98, v16, v17
    v_lshlrev_b32 v18, 16, v59
    buffer_load_dwordx4 v45, s[20:23], s40 offen offset:1024 lds
    v_and_b32 v19, s46, v59
    v_fma_f32 v18, v18, v166, v174
    v_fma_f32 v19, v19, v167, v175
    v_cvt_pk_bf16_f32 v99, v18, v19
    v_mfma_f32_16x16x32_bf16 a[48:51], v[144:147], v[120:123], a[48:51]
    buffer_load_dwordx4 v[56:59], v21, s[28:31], s41 offen
    v_lshlrev_b32 v16, 16, v60
    v_and_b32 v17, s46, v60
    v_fma_f32 v16, v16, v160, v168
    v_fma_f32 v17, v17, v161, v169
    v_cvt_pk_bf16_f32 v100, v16, v17
    v_lshlrev_b32 v18, 16, v61
    v_mfma_f32_16x16x32_bf16 a[52:55], v[148:151], v[120:123], a[52:55]
    v_and_b32 v19, s46, v61
    v_fma_f32 v18, v18, v162, v170
    v_fma_f32 v19, v19, v163, v171
    v_cvt_pk_bf16_f32 v101, v18, v19
    v_lshlrev_b32 v16, 16, v62
    buffer_load_dwordx4 v46, s[20:23], s40 offen offset:2048 lds
    v_and_b32 v17, s46, v62
    v_mfma_f32_16x16x32_bf16 a[56:59], v[152:155], v[120:123], a[56:59]
    v_fma_f32 v16, v16, v164, v172
    v_fma_f32 v17, v17, v165, v173
    v_cvt_pk_bf16_f32 v102, v16, v17
    v_lshlrev_b32 v18, 16, v63
    v_and_b32 v19, s46, v63
    v_fma_f32 v18, v18, v166, v174
    v_mfma_f32_16x16x32_bf16 a[60:63], v[156:159], v[120:123], a[60:63]
    v_fma_f32 v19, v19, v167, v175
    v_cvt_pk_bf16_f32 v103, v18, v19
    buffer_load_dwordx4 v[60:63], v22, s[28:31], s41 offen
    v_lshlrev_b32 v16, 16, v64
    v_and_b32 v17, s46, v64
    v_fma_f32 v16, v16, v160, v168
    v_fma_f32 v17, v17, v161, v169
    v_mfma_f32_16x16x32_bf16 a[64:67], v[144:147], v[124:127], a[64:67]
    v_cvt_pk_bf16_f32 v104, v16, v17
    v_lshlrev_b32 v18, 16, v65
    buffer_load_dwordx4 v47, s[20:23], s40 offen offset:3072 lds
    s_add_u32 s40, s40, 110592
    v_and_b32 v19, s46, v65
    v_fma_f32 v18, v18, v162, v170
    v_fma_f32 v19, v19, v163, v171
    v_cvt_pk_bf16_f32 v105, v18, v19
    v_mfma_f32_16x16x32_bf16 a[68:71], v[148:151], v[124:127], a[68:71]
    v_lshlrev_b32 v16, 16, v66
    v_and_b32 v17, s46, v66
    v_fma_f32 v16, v16, v164, v172
    v_fma_f32 v17, v17, v165, v173
    v_cvt_pk_bf16_f32 v106, v16, v17
    v_lshlrev_b32 v18, 16, v67
    v_mfma_f32_16x16x32_bf16 a[72:75], v[152:155], v[124:127], a[72:75]
    v_and_b32 v19, s46, v67
    v_fma_f32 v18, v18, v166, v174
    v_fma_f32 v19, v19, v167, v175
    v_cvt_pk_bf16_f32 v107, v18, v19
    buffer_load_dwordx4 v[64:67], v23, s[28:31], s41 offen
    s_add_u32 s41, s41, 1024
    v_mfma_f32_16x16x32_bf16 a[76:79], v[156:159], v[124:127], a[76:79]
    s_waitcnt vmcnt(9) lgkmcnt(0)
    ds_read_b128 v[160:163], v15
    ds_read_b128 v[164:167], v15 offset:64
    ds_read_b128 v[168:171], v15 offset:1024
    ds_read_b128 v[172:175], v15 offset:1088
    v_add_u32 v15, 128, v15
    ds_read_b64_tr_b16 v[144:145], v6 offset:4096
    ds_read_b64_tr_b16 v[146:147], v6 offset:6144
    ds_read_b64_tr_b16 v[148:149], v7 offset:4096
    ds_read_b64_tr_b16 v[150:151], v7 offset:6144
    ds_read_b64_tr_b16 v[152:153], v8 offset:4096
    ds_read_b64_tr_b16 v[154:155], v8 offset:6144
    ds_read_b64_tr_b16 v[156:157], v9 offset:4096
    ds_read_b64_tr_b16 v[158:159], v9 offset:6144
    v_mfma_f32_16x16x32_bf16 a[0:3], v[128:131], v[88:91], a[0:3]
    v_mfma_f32_16x16x32_bf16 a[4:7], v[132:135], v[88:91], a[4:7]
    v_mfma_f32_16x16x32_bf16 a[8:11], v[136:139], v[88:91], a[8:11]
    s_waitcnt lgkmcnt(8)
    v_lshlrev_b32 v16, 16, v68
    v_and_b32 v17, s46, v68
    v_fma_f32 v16, v16, v160, v168
    v_fma_f32 v17, v17, v161, v169
    v_cvt_pk_bf16_f32 v108, v16, v17
    v_lshlrev_b32 v18, 16, v69
    v_mfma_f32_16x16x32_bf16 a[12:15], v[140:143], v[88:91], a[12:15]
    v_and_b32 v19, s46, v69
    v_fma_f32 v18, v18, v162, v170
    v_fma_f32 v19, v19, v163, v171
    v_cvt_pk_bf16_f32 v109, v18, v19
    v_lshlrev_b32 v16, 16, v70
    v_and_b32 v17, s46, v70
    v_mfma_f32_16x16x32_bf16 a[16:19], v[128:131], v[92:95], a[16:19]
    v_fma_f32 v16, v16, v164, v172
    v_fma_f32 v17, v17, v165, v173
    v_cvt_pk_bf16_f32 v110, v16, v17
    v_lshlrev_b32 v18, 16, v71
    v_and_b32 v19, s46, v71
    v_fma_f32 v18, v18, v166, v174
    v_mfma_f32_16x16x32_bf16 a[20:23], v[132:135], v[92:95], a[20:23]
    v_fma_f32 v19, v19, v167, v175
    v_cvt_pk_bf16_f32 v111, v18, v19
    buffer_load_dwordx4 v[68:71], v3, s[28:31], s41 offen
    v_lshlrev_b32 v16, 16, v72
    v_and_b32 v17, s46, v72
    v_fma_f32 v16, v16, v160, v168
    v_fma_f32 v17, v17, v161, v169
    v_mfma_f32_16x16x32_bf16 a[24:27], v[136:139], v[92:95], a[24:27]
    v_cvt_pk_bf16_f32 v112, v16, v17
    v_lshlrev_b32 v18, 16, v73
    v_and_b32 v19, s46, v73
    v_fma_f32 v18, v18, v162, v170
    v_fma_f32 v19, v19, v163, v171
    v_cvt_pk_bf16_f32 v113, v18, v19
    v_mfma_f32_16x16x32_bf16 a[28:31], v[140:143], v[92:95], a[28:31]
    v_lshlrev_b32 v16, 16, v74
    s_waitcnt lgkmcnt(0)
    v_and_b32 v17, s46, v74
    v_fma_f32 v16, v16, v164, v172
    v_fma_f32 v17, v17, v165, v173
    v_cvt_pk_bf16_f32 v114, v16, v17
    v_lshlrev_b32 v18, 16, v75
    v_mfma_f32_16x16x32_bf16 a[32:35], v[128:131], v[96:99], a[32:35]
    v_and_b32 v19, s46, v75
    v_fma_f32 v18, v18, v166, v174
    v_fma_f32 v19, v19, v167, v175
    v_cvt_pk_bf16_f32 v115, v18, v19
    buffer_load_dwordx4 v[72:75], v20, s[28:31], s41 offen
    v_lshlrev_b32 v16, 16, v76
    s_mov_b32 m0, s65
    s_nop 0
    buffer_load_dwordx4 v44, s[20:23], s40 offen offset:0 lds
    v_and_b32 v17, s46, v76
    v_mfma_f32_16x16x32_bf16 a[36:39], v[132:135], v[96:99], a[36:39]
    v_fma_f32 v16, v16, v160, v168
    v_fma_f32 v17, v17, v161, v169
    v_cvt_pk_bf16_f32 v116, v16, v17
    v_lshlrev_b32 v18, 16, v77
    v_and_b32 v19, s46, v77
    v_fma_f32 v18, v18, v162, v170
    v_mfma_f32_16x16x32_bf16 a[40:43], v[136:139], v[96:99], a[40:43]
    v_fma_f32 v19, v19, v163, v171
    v_cvt_pk_bf16_f32 v117, v18, v19
    v_lshlrev_b32 v16, 16, v78
    v_and_b32 v17, s46, v78
    v_fma_f32 v16, v16, v164, v172
    v_fma_f32 v17, v17, v165, v173
    v_mfma_f32_16x16x32_bf16 a[44:47], v[140:143], v[96:99], a[44:47]
    v_cvt_pk_bf16_f32 v118, v16, v17
    v_lshlrev_b32 v18, 16, v79
    buffer_load_dwordx4 v45, s[20:23], s40 offen offset:1024 lds
    v_and_b32 v19, s46, v79
    v_fma_f32 v18, v18, v166, v174
    v_fma_f32 v19, v19, v167, v175
    v_cvt_pk_bf16_f32 v119, v18, v19
    v_mfma_f32_16x16x32_bf16 a[48:51], v[128:131], v[100:103], a[48:51]
    buffer_load_dwordx4 v[76:79], v21, s[28:31], s41 offen
    v_lshlrev_b32 v16, 16, v80
    v_and_b32 v17, s46, v80
    v_fma_f32 v16, v16, v160, v168
    v_fma_f32 v17, v17, v161, v169
    v_cvt_pk_bf16_f32 v120, v16, v17
    v_lshlrev_b32 v18, 16, v81
    v_mfma_f32_16x16x32_bf16 a[52:55], v[132:135], v[100:103], a[52:55]
    v_and_b32 v19, s46, v81
    v_fma_f32 v18, v18, v162, v170
    v_fma_f32 v19, v19, v163, v171
    v_cvt_pk_bf16_f32 v121, v18, v19
    v_lshlrev_b32 v16, 16, v82
    buffer_load_dwordx4 v46, s[20:23], s40 offen offset:2048 lds
    v_and_b32 v17, s46, v82
    v_mfma_f32_16x16x32_bf16 a[56:59], v[136:139], v[100:103], a[56:59]
    v_fma_f32 v16, v16, v164, v172
    v_fma_f32 v17, v17, v165, v173
    v_cvt_pk_bf16_f32 v122, v16, v17
    v_lshlrev_b32 v18, 16, v83
    v_and_b32 v19, s46, v83
    v_fma_f32 v18, v18, v166, v174
    v_mfma_f32_16x16x32_bf16 a[60:63], v[140:143], v[100:103], a[60:63]
    v_fma_f32 v19, v19, v167, v175
    v_cvt_pk_bf16_f32 v123, v18, v19
    buffer_load_dwordx4 v[80:83], v22, s[28:31], s41 offen
    v_lshlrev_b32 v16, 16, v84
    v_and_b32 v17, s46, v84
    v_fma_f32 v16, v16, v160, v168
    v_fma_f32 v17, v17, v161, v169
    v_mfma_f32_16x16x32_bf16 a[64:67], v[128:131], v[104:107], a[64:67]
    v_cvt_pk_bf16_f32 v124, v16, v17
    v_lshlrev_b32 v18, 16, v85
    buffer_load_dwordx4 v47, s[20:23], s40 offen offset:3072 lds
    s_add_u32 s40, s40, 110592
    v_and_b32 v19, s46, v85
    v_fma_f32 v18, v18, v162, v170
    v_fma_f32 v19, v19, v163, v171
    v_cvt_pk_bf16_f32 v125, v18, v19
    v_mfma_f32_16x16x32_bf16 a[68:71], v[132:135], v[104:107], a[68:71]
    v_lshlrev_b32 v16, 16, v86
    v_and_b32 v17, s46, v86
    v_fma_f32 v16, v16, v164, v172
    v_fma_f32 v17, v17, v165, v173
    v_cvt_pk_bf16_f32 v126, v16, v17
    v_lshlrev_b32 v18, 16, v87
    v_mfma_f32_16x16x32_bf16 a[72:75], v[136:139], v[104:107], a[72:75]
    v_and_b32 v19, s46, v87
    v_fma_f32 v18, v18, v166, v174
    v_fma_f32 v19, v19, v167, v175
    v_cvt_pk_bf16_f32 v127, v18, v19
    buffer_load_dwordx4 v[84:87], v23, s[28:31], s41 offen
    s_add_u32 s41, s41, 1024
    v_mfma_f32_16x16x32_bf16 a[76:79], v[140:143], v[104:107], a[76:79]
    s_waitcnt vmcnt(9) lgkmcnt(0)
    ds_read_b128 v[160:163], v15
    ds_read_b128 v[164:167], v15 offset:64
    ds_read_b128 v[168:171], v15 offset:1024
    ds_read_b128 v[172:175], v15 offset:1088
    v_add_u32 v15, 128, v15
    ds_read_b64_tr_b16 v[128:129], v6 offset:0
    ds_read_b64_tr_b16 v[130:131], v6 offset:2048
    ds_read_b64_tr_b16 v[132:133], v7 offset:0
    ds_read_b64_tr_b16 v[134:135], v7 offset:2048
    ds_read_b64_tr_b16 v[136:137], v8 offset:0
    ds_read_b64_tr_b16 v[138:139], v8 offset:2048
    ds_read_b64_tr_b16 v[140:141], v9 offset:0
    ds_read_b64_tr_b16 v[142:143], v9 offset:2048
    v_mfma_f32_16x16x32_bf16 a[0:3], v[144:147], v[108:111], a[0:3]
    v_mfma_f32_16x16x32_bf16 a[4:7], v[148:151], v[108:111], a[4:7]
    v_mfma_f32_16x16x32_bf16 a[8:11], v[152:155], v[108:111], a[8:11]
    s_waitcnt lgkmcnt(8)
    v_lshlrev_b32 v16, 16, v48
    v_and_b32 v17, s46, v48
    v_fma_f32 v16, v16, v160, v168
    v_fma_f32 v17, v17, v161, v169
    v_cvt_pk_bf16_f32 v88, v16, v17
    v_lshlrev_b32 v18, 16, v49
    v_mfma_f32_16x16x32_bf16 a[12:15], v[156:159], v[108:111], a[12:15]
    v_and_b32 v19, s46, v49
    v_fma_f32 v18, v18, v162, v170
    v_fma_f32 v19, v19, v163, v171
    v_cvt_pk_bf16_f32 v89, v18, v19
    v_lshlrev_b32 v16, 16, v50
    v_and_b32 v17, s46, v50
    v_mfma_f32_16x16x32_bf16 a[16:19], v[144:147], v[112:115], a[16:19]
    v_fma_f32 v16, v16, v164, v172
    v_fma_f32 v17, v17, v165, v173
    v_cvt_pk_bf16_f32 v90, v16, v17
    v_lshlrev_b32 v18, 16, v51
    v_and_b32 v19, s46, v51
    v_fma_f32 v18, v18, v166, v174
    v_mfma_f32_16x16x32_bf16 a[20:23], v[148:151], v[112:115], a[20:23]
    v_fma_f32 v19, v19, v167, v175
    v_cvt_pk_bf16_f32 v91, v18, v19
    v_lshlrev_b32 v16, 16, v52
    v_and_b32 v17, s46, v52
    v_fma_f32 v16, v16, v160, v168
    v_fma_f32 v17, v17, v161, v169
    v_mfma_f32_16x16x32_bf16 a[24:27], v[152:155], v[112:115], a[24:27]
    v_cvt_pk_bf16_f32 v92, v16, v17
    v_lshlrev_b32 v18, 16, v53
    v_and_b32 v19, s46, v53
    v_fma_f32 v18, v18, v162, v170
    v_fma_f32 v19, v19, v163, v171
    v_cvt_pk_bf16_f32 v93, v18, v19
    v_mfma_f32_16x16x32_bf16 a[28:31], v[156:159], v[112:115], a[28:31]
    v_lshlrev_b32 v16, 16, v54
    v_and_b32 v17, s46, v54
    v_fma_f32 v16, v16, v164, v172
    v_fma_f32 v17, v17, v165, v173
    v_cvt_pk_bf16_f32 v94, v16, v17
    v_lshlrev_b32 v18, 16, v55
    v_mfma_f32_16x16x32_bf16 a[32:35], v[144:147], v[116:119], a[32:35]
    v_and_b32 v19, s46, v55
    v_fma_f32 v18, v18, v166, v174
    v_fma_f32 v19, v19, v167, v175
    v_cvt_pk_bf16_f32 v95, v18, v19
    v_lshlrev_b32 v16, 16, v56
    v_and_b32 v17, s46, v56
    v_mfma_f32_16x16x32_bf16 a[36:39], v[148:151], v[116:119], a[36:39]
    v_fma_f32 v16, v16, v160, v168
    v_fma_f32 v17, v17, v161, v169
    v_cvt_pk_bf16_f32 v96, v16, v17
    v_lshlrev_b32 v18, 16, v57
    v_and_b32 v19, s46, v57
    v_fma_f32 v18, v18, v162, v170
    v_mfma_f32_16x16x32_bf16 a[40:43], v[152:155], v[116:119], a[40:43]
    v_fma_f32 v19, v19, v163, v171
    v_cvt_pk_bf16_f32 v97, v18, v19
    v_lshlrev_b32 v16, 16, v58
    v_and_b32 v17, s46, v58
    v_fma_f32 v16, v16, v164, v172
    v_fma_f32 v17, v17, v165, v173
    v_mfma_f32_16x16x32_bf16 a[44:47], v[156:159], v[116:119], a[44:47]
    v_cvt_pk_bf16_f32 v98, v16, v17
    v_lshlrev_b32 v18, 16, v59
    v_and_b32 v19, s46, v59
    v_fma_f32 v18, v18, v166, v174
    v_fma_f32 v19, v19, v167, v175
    v_cvt_pk_bf16_f32 v99, v18, v19
    v_mfma_f32_16x16x32_bf16 a[48:51], v[144:147], v[120:123], a[48:51]
    v_lshlrev_b32 v16, 16, v60
    v_and_b32 v17, s46, v60
    v_fma_f32 v16, v16, v160, v168
    v_fma_f32 v17, v17, v161, v169
    v_cvt_pk_bf16_f32 v100, v16, v17
    v_lshlrev_b32 v18, 16, v61
    v_mfma_f32_16x16x32_bf16 a[52:55], v[148:151], v[120:123], a[52:55]
    v_and_b32 v19, s46, v61
    v_fma_f32 v18, v18, v162, v170
    v_fma_f32 v19, v19, v163, v171
    v_cvt_pk_bf16_f32 v101, v18, v19
    v_lshlrev_b32 v16, 16, v62
    v_and_b32 v17, s46, v62
    v_mfma_f32_16x16x32_bf16 a[56:59], v[152:155], v[120:123], a[56:59]
    v_fma_f32 v16, v16, v164, v172
    v_fma_f32 v17, v17, v165, v173
    v_cvt_pk_bf16_f32 v102, v16, v17
    v_lshlrev_b32 v18, 16, v63
    v_and_b32 v19, s46, v63
    v_fma_f32 v18, v18, v166, v174
    v_mfma_f32_16x16x32_bf16 a[60:63], v[156:159], v[120:123], a[60:63]
    v_fma_f32 v19, v19, v167, v175
    v_cvt_pk_bf16_f32 v103, v18, v19
    v_lshlrev_b32 v16, 16, v64
    v_and_b32 v17, s46, v64
    v_fma_f32 v16, v16, v160, v168
    v_fma_f32 v17, v17, v161, v169
    v_mfma_f32_16x16x32_bf16 a[64:67], v[144:147], v[124:127], a[64:67]
    v_cvt_pk_bf16_f32 v104, v16, v17
    v_lshlrev_b32 v18, 16, v65
    v_and_b32 v19, s46, v65
    v_fma_f32 v18, v18, v162, v170
    v_fma_f32 v19, v19, v163, v171
    v_cvt_pk_bf16_f32 v105, v18, v19
    v_mfma_f32_16x16x32_bf16 a[68:71], v[148:151], v[124:127], a[68:71]
    v_lshlrev_b32 v16, 16, v66
    v_and_b32 v17, s46, v66
    v_fma_f32 v16, v16, v164, v172
    v_fma_f32 v17, v17, v165, v173
    v_cvt_pk_bf16_f32 v106, v16, v17
    v_lshlrev_b32 v18, 16, v67
    v_mfma_f32_16x16x32_bf16 a[72:75], v[152:155], v[124:127], a[72:75]
    v_and_b32 v19, s46, v67
    v_fma_f32 v18, v18, v166, v174
    v_fma_f32 v19, v19, v167, v175
    v_cvt_pk_bf16_f32 v107, v18, v19
    v_mfma_f32_16x16x32_bf16 a[76:79], v[156:159], v[124:127], a[76:79]
    s_setprio 0
    s_waitcnt vmcnt(0) lgkmcnt(0)
    ds_read_b128 v[160:163], v15
    ds_read_b128 v[164:167], v15 offset:64
    ds_read_b128 v[168:171], v15 offset:1024
    ds_read_b128 v[172:175], v15 offset:1088
    v_add_u32 v15, 128, v15
    ds_read_b64_tr_b16 v[144:145], v6 offset:4096
    ds_read_b64_tr_b16 v[146:147], v6 offset:6144
    ds_read_b64_tr_b16 v[148:149], v7 offset:4096
    ds_read_b64_tr_b16 v[150:151], v7 offset:6144
    ds_read_b64_tr_b16 v[152:153], v8 offset:4096
    ds_read_b64_tr_b16 v[154:155], v8 offset:6144
    ds_read_b64_tr_b16 v[156:157], v9 offset:4096
    ds_read_b64_tr_b16 v[158:159], v9 offset:6144
    v_mfma_f32_16x16x32_bf16 a[0:3], v[128:131], v[88:91], a[0:3]
    v_mfma_f32_16x16x32_bf16 a[4:7], v[132:135], v[88:91], a[4:7]
    v_mfma_f32_16x16x32_bf16 a[8:11], v[136:139], v[88:91], a[8:11]
    s_waitcnt lgkmcnt(8)
    v_lshlrev_b32 v16, 16, v68
    v_and_b32 v17, s46, v68
    v_fma_f32 v16, v16, v160, v168
    v_fma_f32 v17, v17, v161, v169
    v_cvt_pk_bf16_f32 v108, v16, v17
    v_lshlrev_b32 v18, 16, v69
    v_mfma_f32_16x16x32_bf16 a[12:15], v[140:143], v[88:91], a[12:15]
    v_and_b32 v19, s46, v69
    v_fma_f32 v18, v18, v162, v170
    v_fma_f32 v19, v19, v163, v171
    v_cvt_pk_bf16_f32 v109, v18, v19
    v_lshlrev_b32 v16, 16, v70
    v_and_b32 v17, s46, v70
    v_mfma_f32_16x16x32_bf16 a[16:19], v[128:131], v[92:95], a[16:19]
    v_fma_f32 v16, v16, v164, v172
    v_fma_f32 v17, v17, v165, v173
    v_cvt_pk_bf16_f32 v110, v16, v17
    v_lshlrev_b32 v18, 16, v71
    v_and_b32 v19, s46, v71
    v_fma_f32 v18, v18, v166, v174
    v_mfma_f32_16x16x32_bf16 a[20:23], v[132:135], v[92:95], a[20:23]
    v_fma_f32 v19, v19, v167, v175
    v_cvt_pk_bf16_f32 v111, v18, v19
    v_lshlrev_b32 v16, 16, v72
    v_and_b32 v17, s46, v72
    v_fma_f32 v16, v16, v160, v168
    v_fma_f32 v17, v17, v161, v169
    v_mfma_f32_16x16x32_bf16 a[24:27], v[136:139], v[92:95], a[24:27]
    v_cvt_pk_bf16_f32 v112, v16, v17
    v_lshlrev_b32 v18, 16, v73
    v_and_b32 v19, s46, v73
    v_fma_f32 v18, v18, v162, v170
    v_fma_f32 v19, v19, v163, v171
    v_cvt_pk_bf16_f32 v113, v18, v19
    v_mfma_f32_16x16x32_bf16 a[28:31], v[140:143], v[92:95], a[28:31]
    v_lshlrev_b32 v16, 16, v74
    v_and_b32 v17, s46, v74
    v_fma_f32 v16, v16, v164, v172
    v_fma_f32 v17, v17, v165, v173
    v_cvt_pk_bf16_f32 v114, v16, v17
    v_lshlrev_b32 v18, 16, v75
    v_mfma_f32_16x16x32_bf16 a[32:35], v[128:131], v[96:99], a[32:35]
    v_and_b32 v19, s46, v75
    v_fma_f32 v18, v18, v166, v174
    v_fma_f32 v19, v19, v167, v175
    v_cvt_pk_bf16_f32 v115, v18, v19
    v_lshlrev_b32 v16, 16, v76
    v_and_b32 v17, s46, v76
    v_mfma_f32_16x16x32_bf16 a[36:39], v[132:135], v[96:99], a[36:39]
    v_fma_f32 v16, v16, v160, v168
    v_fma_f32 v17, v17, v161, v169
    v_cvt_pk_bf16_f32 v116, v16, v17
    v_lshlrev_b32 v18, 16, v77
    v_and_b32 v19, s46, v77
    v_fma_f32 v18, v18, v162, v170
    v_mfma_f32_16x16x32_bf16 a[40:43], v[136:139], v[96:99], a[40:43]
    v_fma_f32 v19, v19, v163, v171
    v_cvt_pk_bf16_f32 v117, v18, v19
    v_lshlrev_b32 v16, 16, v78
    v_and_b32 v17, s46, v78
    v_fma_f32 v16, v16, v164, v172
    v_fma_f32 v17, v17, v165, v173
    v_mfma_f32_16x16x32_bf16 a[44:47], v[140:143], v[96:99], a[44:47]
    v_cvt_pk_bf16_f32 v118, v16, v17
    v_lshlrev_b32 v18, 16, v79
    v_and_b32 v19, s46, v79
    v_fma_f32 v18, v18, v166, v174
    v_fma_f32 v19, v19, v167, v175
    v_cvt_pk_bf16_f32 v119, v18, v19
    v_mfma_f32_16x16x32_bf16 a[48:51], v[128:131], v[100:103], a[48:51]
    v_lshlrev_b32 v16, 16, v80
    v_and_b32 v17, s46, v80
    v_fma_f32 v16, v16, v160, v168
    v_fma_f32 v17, v17, v161, v169
    v_cvt_pk_bf16_f32 v120, v16, v17
    v_lshlrev_b32 v18, 16, v81
    v_mfma_f32_16x16x32_bf16 a[52:55], v[132:135], v[100:103], a[52:55]
    v_and_b32 v19, s46, v81
    v_fma_f32 v18, v18, v162, v170
    v_fma_f32 v19, v19, v163, v171
    v_cvt_pk_bf16_f32 v121, v18, v19
    v_lshlrev_b32 v16, 16, v82
    v_and_b32 v17, s46, v82
    v_mfma_f32_16x16x32_bf16 a[56:59], v[136:139], v[100:103], a[56:59]
    v_fma_f32 v16, v16, v164, v172
    v_fma_f32 v17, v17, v165, v173
    v_cvt_pk_bf16_f32 v122, v16, v17
    v_lshlrev_b32 v18, 16, v83
    v_and_b32 v19, s46, v83
    v_fma_f32 v18, v18, v166, v174
    v_mfma_f32_16x16x32_bf16 a[60:63], v[140:143], v[100:103], a[60:63]
    v_fma_f32 v19, v19, v167, v175
    v_cvt_pk_bf16_f32 v123, v18, v19
    v_lshlrev_b32 v16, 16, v84
    v_and_b32 v17, s46, v84
    v_fma_f32 v16, v16, v160, v168
    v_fma_f32 v17, v17, v161, v169
    v_mfma_f32_16x16x32_bf16 a[64:67], v[128:131], v[104:107], a[64:67]
    v_cvt_pk_bf16_f32 v124, v16, v17
    v_lshlrev_b32 v18, 16, v85
    v_and_b32 v19, s46, v85
    v_fma_f32 v18, v18, v162, v170
    v_fma_f32 v19, v19, v163, v171
    v_cvt_pk_bf16_f32 v125, v18, v19
    v_mfma_f32_16x16x32_bf16 a[68:71], v[132:135], v[104:107], a[68:71]
    v_lshlrev_b32 v16, 16, v86
    v_and_b32 v17, s46, v86
    v_fma_f32 v16, v16, v164, v172
    v_fma_f32 v17, v17, v165, v173
    v_cvt_pk_bf16_f32 v126, v16, v17
    v_lshlrev_b32 v18, 16, v87
    v_mfma_f32_16x16x32_bf16 a[72:75], v[136:139], v[104:107], a[72:75]
    v_and_b32 v19, s46, v87
    v_fma_f32 v18, v18, v166, v174
    v_fma_f32 v19, v19, v167, v175
    v_cvt_pk_bf16_f32 v127, v18, v19
    v_mfma_f32_16x16x32_bf16 a[76:79], v[140:143], v[104:107], a[76:79]
    s_waitcnt lgkmcnt(0)
    v_mfma_f32_16x16x32_bf16 a[0:3], v[144:147], v[108:111], a[0:3]
    v_mfma_f32_16x16x32_bf16 a[4:7], v[148:151], v[108:111], a[4:7]
    v_mfma_f32_16x16x32_bf16 a[8:11], v[152:155], v[108:111], a[8:11]
    v_mfma_f32_16x16x32_bf16 a[12:15], v[156:159], v[108:111], a[12:15]
    v_mfma_f32_16x16x32_bf16 a[16:19], v[144:147], v[112:115], a[16:19]
    v_mfma_f32_16x16x32_bf16 a[20:23], v[148:151], v[112:115], a[20:23]
    v_mfma_f32_16x16x32_bf16 a[24:27], v[152:155], v[112:115], a[24:27]
    v_mfma_f32_16x16x32_bf16 a[28:31], v[156:159], v[112:115], a[28:31]
    v_mfma_f32_16x16x32_bf16 a[32:35], v[144:147], v[116:119], a[32:35]
    v_mfma_f32_16x16x32_bf16 a[36:39], v[148:151], v[116:119], a[36:39]
    v_mfma_f32_16x16x32_bf16 a[40:43], v[152:155], v[116:119], a[40:43]
    v_mfma_f32_16x16x32_bf16 a[44:47], v[156:159], v[116:119], a[44:47]
    v_mfma_f32_16x16x32_bf16 a[48:51], v[144:147], v[120:123], a[48:51]
    v_mfma_f32_16x16x32_bf16 a[52:55], v[148:151], v[120:123], a[52:55]
    v_mfma_f32_16x16x32_bf16 a[56:59], v[152:155], v[120:123], a[56:59]
    v_mfma_f32_16x16x32_bf16 a[60:63], v[156:159], v[120:123], a[60:63]
    v_mfma_f32_16x16x32_bf16 a[64:67], v[144:147], v[124:127], a[64:67]
    v_mfma_f32_16x16x32_bf16 a[68:71], v[148:151], v[124:127], a[68:71]
    v_mfma_f32_16x16x32_bf16 a[72:75], v[152:155], v[124:127], a[72:75]
    v_mfma_f32_16x16x32_bf16 a[76:79], v[156:159], v[124:127], a[76:79]
L_mlp1_0_kernel_done:
    s_waitcnt vmcnt(0) lgkmcnt(0)
    s_cmp_lg_u32 s34, 26
    s_cbranch_scc1 L_mlp1_0_kernel_nozf
    s_cmp_ge_u32 s32, 5
    s_cbranch_scc1 L_mlp1_0_kernel_nozf
    s_mul_i32 s43, s33, 5
    s_add_u32 s43, s43, s32
    s_mul_i32 s43, s43, 57344
    s_add_u32 s43, s43, 11589632
    v_mov_b32 v16, 0
    v_mov_b32 v17, 0
    v_mov_b32 v18, 0
    v_mov_b32 v19, 0
    buffer_store_dwordx4 v[16:19], v3, s[28:31], s43 offen
    buffer_store_dwordx4 v[16:19], v3, s[28:31], s43 offen offset:1024
L_mlp1_0_kernel_nozf:
    s_mov_b32 s56, s8
    s_and_b32 s57, s9, 0xffff
    s_mov_b32 s58, 0x6c0000
    s_mov_b32 s59, 0x00020000
    s_lshr_b32 s43, s2, 3
    s_lshl_b32 s43, s43, 3
    s_add_u32 s43, s43, s32
    s_mul_i32 s43, s43, 32768
    s_and_b32 s44, s2, 7
    s_lshl_b32 s44, s44, 7
    s_add_u32 s43, s43, s44
    v_lshrrev_b32 v10, 3, v0
    v_lshlrev_b32 v10, 12, v10
    v_and_b32 v11, 7, v0
    v_lshl_add_u32 v10, v11, 4, v10
    buffer_load_dwordx4 v[20:23], v10, s[56:59], s43 offen offset:0
    buffer_load_dwordx4 v[20:23], v10, s[56:59], s43 offen offset:1024
    buffer_load_dwordx4 v[20:23], v10, s[56:59], s43 offen offset:2048
    buffer_load_dwordx4 v[20:23], v10, s[56:59], s43 offen offset:3072
    s_getpc_b64 s[90:91]
L_pc_ref3:
    s_sub_u32 s90, s90, L_pc_ref3 - L_text_start
    s_subb_u32 s91, s91, 0
    s_lshr_b32 s92, s2, 3
    s_mul_i32 s92, s92, 8
    s_add_u32 s92, s92, s32
    s_lshl_b32 s92, s92, 9
    s_min_u32 s92, s92, L_text_end - L_text_start - 512
    s_add_u32 s90, s90, s92
    s_addc_u32 s91, s91, 0
    v_lshlrev_b32 v12, 3, v0
    global_load_dwordx2 v[20:21], v12, s[90:91]
    s_barrier
    s_cmp_eq_u32 s32, 0
    s_cbranch_scc1 L_mlp1_0_kernel_own0
    s_sub_u32 s43, s32, 1
    s_and_b32 s43, s43, 7
    s_mul_i32 s43, s43, 3072
    s_add_u32 s43, s43, 0
    v_add_u32 v10, s43, v3
    ds_write_b128 v10, a[0:3] offset:0
    ds_write_b128 v10, a[16:19] offset:1024
    ds_write_b128 v10, a[32:35] offset:2048
    s_branch L_mlp1_0_kernel_nx0
L_mlp1_0_kernel_own0:
    v_accvgpr_read_b32 v88, a0
    v_accvgpr_read_b32 v89, a1
    v_accvgpr_read_b32 v90, a2
    v_accvgpr_read_b32 v91, a3
    v_accvgpr_read_b32 v92, a16
    v_accvgpr_read_b32 v93, a17
    v_accvgpr_read_b32 v94, a18
    v_accvgpr_read_b32 v95, a19
    v_accvgpr_read_b32 v96, a32
    v_accvgpr_read_b32 v97, a33
    v_accvgpr_read_b32 v98, a34
    v_accvgpr_read_b32 v99, a35
    s_mov_b32 s54, 0
    s_mov_b32 s55, 3072
L_mlp1_0_kernel_nx0:
    s_cmp_eq_u32 s32, 1
    s_cbranch_scc1 L_mlp1_0_kernel_own1
    s_sub_u32 s43, s32, 2
    s_and_b32 s43, s43, 7
    s_mul_i32 s43, s43, 3072
    s_add_u32 s43, s43, 21504
    v_add_u32 v10, s43, v3
    ds_write_b128 v10, a[4:7] offset:0
    ds_write_b128 v10, a[20:23] offset:1024
    ds_write_b128 v10, a[36:39] offset:2048
    s_branch L_mlp1_0_kernel_nx1
L_mlp1_0_kernel_own1:
    v_accvgpr_read_b32 v88, a4
    v_accvgpr_read_b32 v89, a5
    v_accvgpr_read_b32 v90, a6
    v_accvgpr_read_b32 v91, a7
    v_accvgpr_read_b32 v92, a20
    v_accvgpr_read_b32 v93, a21
    v_accvgpr_read_b32 v94, a22
    v_accvgpr_read_b32 v95, a23
    v_accvgpr_read_b32 v96, a36
    v_accvgpr_read_b32 v97, a37
    v_accvgpr_read_b32 v98, a38
    v_accvgpr_read_b32 v99, a39
    s_mov_b32 s54, 21504
    s_mov_b32 s55, 3072
L_mlp1_0_kernel_nx1:
    s_cmp_eq_u32 s32, 2
    s_cbranch_scc1 L_mlp1_0_kernel_own2
    s_sub_u32 s43, s32, 3
    s_and_b32 s43, s43, 7
    s_mul_i32 s43, s43, 3072
    s_add_u32 s43, s43, 43008
    v_add_u32 v10, s43, v3
    ds_write_b128 v10, a[8:11] offset:0
    ds_write_b128 v10, a[24:27] offset:1024
    ds_write_b128 v10, a[40:43] offset:2048
    s_branch L_mlp1_0_kernel_nx2
L_mlp1_0_kernel_own2:
    v_accvgpr_read_b32 v88, a8
    v_accvgpr_read_b32 v89, a9
    v_accvgpr_read_b32 v90, a10
    v_accvgpr_read_b32 v91, a11
    v_accvgpr_read_b32 v92, a24
    v_accvgpr_read_b32 v93, a25
    v_accvgpr_read_b32 v94, a26
    v_accvgpr_read_b32 v95, a27
    v_accvgpr_read_b32 v96, a40
    v_accvgpr_read_b32 v97, a41
    v_accvgpr_read_b32 v98, a42
    v_accvgpr_read_b32 v99, a43
    s_mov_b32 s54, 43008
    s_mov_b32 s55, 3072
L_mlp1_0_kernel_nx2:
    s_cmp_eq_u32 s32, 3
    s_cbranch_scc1 L_mlp1_0_kernel_own3
    s_sub_u32 s43, s32, 4
    s_and_b32 s43, s43, 7
    s_mul_i32 s43, s43, 3072
    s_add_u32 s43, s43, 64512
    v_add_u32 v10, s43, v3
    ds_write_b128 v10, a[12:15] offset:0
    ds_write_b128 v10, a[28:31] offset:1024
    ds_write_b128 v10, a[44:47] offset:2048
    s_branch L_mlp1_0_kernel_nx3
L_mlp1_0_kernel_own3:
    v_accvgpr_read_b32 v88, a12
    v_accvgpr_read_b32 v89, a13
    v_accvgpr_read_b32 v90, a14
    v_accvgpr_read_b32 v91, a15
    v_accvgpr_read_b32 v92, a28
    v_accvgpr_read_b32 v93, a29
    v_accvgpr_read_b32 v94, a30
    v_accvgpr_read_b32 v95, a31
    v_accvgpr_read_b32 v96, a44
    v_accvgpr_read_b32 v97, a45
    v_accvgpr_read_b32 v98, a46
    v_accvgpr_read_b32 v99, a47
    s_mov_b32 s54, 64512
    s_mov_b32 s55, 3072
L_mlp1_0_kernel_nx3:
    s_cmp_eq_u32 s32, 4
    s_cbranch_scc1 L_mlp1_0_kernel_own4
    s_sub_u32 s43, s32, 5
    s_and_b32 s43, s43, 7
    s_mul_i32 s43, s43, 2048
    s_add_u32 s43, s43, 86016
    v_add_u32 v10, s43, v3
    ds_write_b128 v10, a[48:51] offset:0
    ds_write_b128 v10, a[64:67] offset:1024
    s_branch L_mlp1_0_kernel_nx4
L_mlp1_0_kernel_own4:
    v_accvgpr_read_b32 v88, a48
    v_accvgpr_read_b32 v89, a49
    v_accvgpr_read_b32 v90, a50
    v_accvgpr_read_b32 v91, a51
    v_accvgpr_read_b32 v92, a64
    v_accvgpr_read_b32 v93, a65
    v_accvgpr_read_b32 v94, a66
    v_accvgpr_read_b32 v95, a67
    v_mov_b32 v96, 0
    v_mov_b32 v97, 0
    v_mov_b32 v98, 0
    v_mov_b32 v99, 0
    s_mov_b32 s54, 86016
    s_mov_b32 s55, 2048
L_mlp1_0_kernel_nx4:
    s_cmp_eq_u32 s32, 5
    s_cbranch_scc1 L_mlp1_0_kernel_own5
    s_sub_u32 s43, s32, 6
    s_and_b32 s43, s43, 7
    s_mul_i32 s43, s43, 2048
    s_add_u32 s43, s43, 100352
    v_add_u32 v10, s43, v3
    ds_write_b128 v10, a[52:55] offset:0
    ds_write_b128 v10, a[68:71] offset:1024
    s_branch L_mlp1_0_kernel_nx5
L_mlp1_0_kernel_own5:
    v_accvgpr_read_b32 v88, a52
    v_accvgpr_read_b32 v89, a53
    v_accvgpr_read_b32 v90, a54
    v_accvgpr_read_b32 v91, a55
    v_accvgpr_read_b32 v92, a68
    v_accvgpr_read_b32 v93, a69
    v_accvgpr_read_b32 v94, a70
    v_accvgpr_read_b32 v95, a71
    v_mov_b32 v96, 0
    v_mov_b32 v97, 0
    v_mov_b32 v98, 0
    v_mov_b32 v99, 0
    s_mov_b32 s54, 100352
    s_mov_b32 s55, 2048
L_mlp1_0_kernel_nx5:
    s_cmp_eq_u32 s32, 6
    s_cbranch_scc1 L_mlp1_0_kernel_own6
    s_sub_u32 s43, s32, 7
    s_and_b32 s43, s43, 7
    s_mul_i32 s43, s43, 2048
    s_add_u32 s43, s43, 114688
    v_add_u32 v10, s43, v3
    ds_write_b128 v10, a[56:59] offset:0
    ds_write_b128 v10, a[72:75] offset:1024
    s_branch L_mlp1_0_kernel_nx6
L_mlp1_0_kernel_own6:
    v_accvgpr_read_b32 v88, a56
    v_accvgpr_read_b32 v89, a57
    v_accvgpr_read_b32 v90, a58
    v_accvgpr_read_b32 v91, a59
    v_accvgpr_read_b32 v92, a72
    v_accvgpr_read_b32 v93, a73
    v_accvgpr_read_b32 v94, a74
    v_accvgpr_read_b32 v95, a75
    v_mov_b32 v96, 0
    v_mov_b32 v97, 0
    v_mov_b32 v98, 0
    v_mov_b32 v99, 0
    s_mov_b32 s54, 114688
    s_mov_b32 s55, 2048
L_mlp1_0_kernel_nx6:
    s_cmp_eq_u32 s32, 7
    s_cbranch_scc1 L_mlp1_0_kernel_own7
    s_sub_u32 s43, s32, 8
    s_and_b32 s43, s43, 7
    s_mul_i32 s43, s43, 2048
    s_add_u32 s43, s43, 129024
    v_add_u32 v10, s43, v3
    ds_write_b128 v10, a[60:63] offset:0
    ds_write_b128 v10, a[76:79] offset:1024
    s_branch L_mlp1_0_kernel_nx7
L_mlp1_0_kernel_own7:
    v_accvgpr_read_b32 v88, a60
    v_accvgpr_read_b32 v89, a61
    v_accvgpr_read_b32 v90, a62
    v_accvgpr_read_b32 v91, a63
    v_accvgpr_read_b32 v92, a76
    v_accvgpr_read_b32 v93, a77
    v_accvgpr_read_b32 v94, a78
    v_accvgpr_read_b32 v95, a79
    v_mov_b32 v96, 0
    v_mov_b32 v97, 0
    v_mov_b32 v98, 0
    v_mov_b32 v99, 0
    s_mov_b32 s54, 129024
    s_mov_b32 s55, 2048
L_mlp1_0_kernel_nx7:
    s_waitcnt lgkmcnt(0)
    s_barrier
    v_add_u32 v10, s54, v3
    v_lshlrev_b32 v40, 16, v24
    v_and_b32 v41, s46, v24
    v_lshlrev_b32 v42, 16, v25
    v_and_b32 v43, s46, v25
    ds_read_b128 v[108:111], v10 offset:0
    ds_read_b128 v[112:115], v10 offset:1024
    ds_read_b128 v[116:119], v10 offset:2048
    v_add_u32 v10, s55, v10
    ds_read_b128 v[120:123], v10 offset:0
    ds_read_b128 v[124:127], v10 offset:1024
    ds_read_b128 v[128:131], v10 offset:2048
    v_add_u32 v10, s55, v10
    ds_read_b128 v[132:135], v10 offset:0
    ds_read_b128 v[136:139], v10 offset:1024
    ds_read_b128 v[140:143], v10 offset:2048
    v_add_u32 v10, s55, v10
    ds_read_b128 v[144:147], v10 offset:0
    ds_read_b128 v[148:151], v10 offset:1024
    ds_read_b128 v[152:155], v10 offset:2048
    v_add_u32 v10, s55, v10
    s_waitcnt lgkmcnt(9)
    v_add_f32 v88, v88, v108
    v_add_f32 v89, v89, v109
    v_add_f32 v90, v90, v110
    v_add_f32 v91, v91, v111
    v_add_f32 v92, v92, v112
    v_add_f32 v93, v93, v113
    v_add_f32 v94, v94, v114
    v_add_f32 v95, v95, v115
    v_add_f32 v96, v96, v116
    v_add_f32 v97, v97, v117
    v_add_f32 v98, v98, v118
    v_add_f32 v99, v99, v119
    ds_read_b128 v[156:159], v10 offset:0
    ds_read_b128 v[160:163], v10 offset:1024
    ds_read_b128 v[164:167], v10 offset:2048
    v_add_u32 v10, s55, v10
    s_waitcnt lgkmcnt(9)
    v_add_f32 v88, v88, v120
    v_add_f32 v89, v89, v121
    v_add_f32 v90, v90, v122
    v_add_f32 v91, v91, v123
    v_add_f32 v92, v92, v124
    v_add_f32 v93, v93, v125
    v_add_f32 v94, v94, v126
    v_add_f32 v95, v95, v127
    v_add_f32 v96, v96, v128
    v_add_f32 v97, v97, v129
    v_add_f32 v98, v98, v130
    v_add_f32 v99, v99, v131
    ds_read_b128 v[48:51], v10 offset:0
    ds_read_b128 v[52:55], v10 offset:1024
    ds_read_b128 v[56:59], v10 offset:2048
    v_add_u32 v10, s55, v10
    s_waitcnt lgkmcnt(9)
    v_add_f32 v88, v88, v132
    v_add_f32 v89, v89, v133
    v_add_f32 v90, v90, v134
    v_add_f32 v91, v91, v135
    v_add_f32 v92, v92, v136
    v_add_f32 v93, v93, v137
    v_add_f32 v94, v94, v138
    v_add_f32 v95, v95, v139
    v_add_f32 v96, v96, v140
    v_add_f32 v97, v97, v141
    v_add_f32 v98, v98, v142
    v_add_f32 v99, v99, v143
    ds_read_b128 v[60:63], v10 offset:0
    ds_read_b128 v[64:67], v10 offset:1024
    ds_read_b128 v[68:71], v10 offset:2048
    s_waitcnt lgkmcnt(9)
    v_add_f32 v88, v88, v144
    v_add_f32 v89, v89, v145
    v_add_f32 v90, v90, v146
    v_add_f32 v91, v91, v147
    v_add_f32 v92, v92, v148
    v_add_f32 v93, v93, v149
    v_add_f32 v94, v94, v150
    v_add_f32 v95, v95, v151
    v_add_f32 v96, v96, v152
    v_add_f32 v97, v97, v153
    v_add_f32 v98, v98, v154
    v_add_f32 v99, v99, v155
    s_waitcnt lgkmcnt(6)
    v_add_f32 v88, v88, v156
    v_add_f32 v89, v89, v157
    v_add_f32 v90, v90, v158
    v_add_f32 v91, v91, v159
    v_add_f32 v92, v92, v160
    v_add_f32 v93, v93, v161
    v_add_f32 v94, v94, v162
    v_add_f32 v95, v95, v163
    v_add_f32 v96, v96, v164
    v_add_f32 v97, v97, v165
    v_add_f32 v98, v98, v166
    v_add_f32 v99, v99, v167
    s_waitcnt lgkmcnt(3)
    v_add_f32 v88, v88, v48
    v_add_f32 v89, v89, v49
    v_add_f32 v90, v90, v50
    v_add_f32 v91, v91, v51
    v_add_f32 v92, v92, v52
    v_add_f32 v93, v93, v53
    v_add_f32 v94, v94, v54
    v_add_f32 v95, v95, v55
    v_add_f32 v96, v96, v56
    v_add_f32 v97, v97, v57
    v_add_f32 v98, v98, v58
    v_add_f32 v99, v99, v59
    s_waitcnt lgkmcnt(0)
    v_add_f32 v88, v88, v60
    v_add_f32 v89, v89, v61
    v_add_f32 v90, v90, v62
    v_add_f32 v91, v91, v63
    v_add_f32 v92, v92, v64
    v_add_f32 v93, v93, v65
    v_add_f32 v94, v94, v66
    v_add_f32 v95, v95, v67
    v_add_f32 v96, v96, v68
    v_add_f32 v97, v97, v69
    v_add_f32 v98, v98, v70
    v_add_f32 v99, v99, v71
    s_mov_b32 s47, 0xc0135761
    s_mov_b32 s48, 0xbdd2d3e8
    v_mov_b32 v44, s47
    s_mul_i32 s43, s33, 286720
    s_mul_i32 s44, s53, 172032
    s_add_u32 s43, s43, s44
    s_lshl_b32 s44, s34, 11
    s_add_u32 s43, s43, s44
    s_lshr_b32 s44, s52, 1
    s_lshl_b32 s44, s44, 10
    s_add_u32 s43, s43, s44
    s_and_b32 s44, s52, 1
    s_lshl_b32 s44, s44, 3
    s_add_u32 s43, s43, s44
    s_add_u32 s43, s43, 11534336
    v_add_f32 v88, v88, v40
    v_add_f32 v89, v89, v41
    v_add_f32 v90, v90, v42
    v_add_f32 v91, v91, v43
    v_mul_f32 v112, v88, v88
    v_mul_f32 v113, v89, v89
    v_mul_f32 v114, v90, v90
    v_mul_f32 v115, v91, v91
    v_fma_f32 v112, v112, s48, v44
    v_fma_f32 v113, v113, s48, v44
    v_fma_f32 v114, v114, s48, v44
    v_fma_f32 v115, v115, s48, v44
    v_mul_f32 v112, v112, v88
    v_mul_f32 v113, v113, v89
    v_mul_f32 v114, v114, v90
    v_mul_f32 v115, v115, v91
    v_exp_f32 v112, v112
    v_exp_f32 v113, v113
    v_exp_f32 v114, v114
    v_exp_f32 v115, v115
    v_add_f32 v112, 1.0, v112
    v_add_f32 v113, 1.0, v113
    v_add_f32 v114, 1.0, v114
    v_add_f32 v115, 1.0, v115
    v_rcp_f32 v112, v112
    v_rcp_f32 v113, v113
    v_rcp_f32 v114, v114
    v_rcp_f32 v115, v115
    v_mul_f32 v88, v88, v112
    v_mul_f32 v89, v89, v113
    v_mul_f32 v90, v90, v114
    v_mul_f32 v91, v91, v115
    v_cvt_pk_bf16_f32 v118, v88, v89
    v_cvt_pk_bf16_f32 v119, v90, v91
    buffer_store_dwordx2 v[118:119], v3, s[28:31], s43 offen
    s_add_u32 s43, s43, 57344
    v_add_f32 v92, v92, v40
    v_add_f32 v93, v93, v41
    v_add_f32 v94, v94, v42
    v_add_f32 v95, v95, v43
    v_mul_f32 v112, v92, v92
    v_mul_f32 v113, v93, v93
    v_mul_f32 v114, v94, v94
    v_mul_f32 v115, v95, v95
    v_fma_f32 v112, v112, s48, v44
    v_fma_f32 v113, v113, s48, v44
    v_fma_f32 v114, v114, s48, v44
    v_fma_f32 v115, v115, s48, v44
    v_mul_f32 v112, v112, v92
    v_mul_f32 v113, v113, v93
    v_mul_f32 v114, v114, v94
    v_mul_f32 v115, v115, v95
    v_exp_f32 v112, v112
    v_exp_f32 v113, v113
    v_exp_f32 v114, v114
    v_exp_f32 v115, v115
    v_add_f32 v112, 1.0, v112
    v_add_f32 v113, 1.0, v113
    v_add_f32 v114, 1.0, v114
    v_add_f32 v115, 1.0, v115
    v_rcp_f32 v112, v112
    v_rcp_f32 v113, v113
    v_rcp_f32 v114, v114
    v_rcp_f32 v115, v115
    v_mul_f32 v92, v92, v112
    v_mul_f32 v93, v93, v113
    v_mul_f32 v94, v94, v114
    v_mul_f32 v95, v95, v115
    v_cvt_pk_bf16_f32 v120, v92, v93
    v_cvt_pk_bf16_f32 v121, v94, v95
    buffer_store_dwordx2 v[120:121], v3, s[28:31], s43 offen
    s_add_u32 s43, s43, 57344
    s_cmp_lg_u32 s53, 0
    s_cbranch_scc1 L_mlp1_0_kernel_fin
    v_add_f32 v96, v96, v40
    v_add_f32 v97, v97, v41
    v_add_f32 v98, v98, v42
    v_add_f32 v99, v99, v43
    v_mul_f32 v112, v96, v96
    v_mul_f32 v113, v97, v97
    v_mul_f32 v114, v98, v98
    v_mul_f32 v115, v99, v99
    v_fma_f32 v112, v112, s48, v44
    v_fma_f32 v113, v113, s48, v44
    v_fma_f32 v114, v114, s48, v44
    v_fma_f32 v115, v115, s48, v44
    v_mul_f32 v112, v112, v96
    v_mul_f32 v113, v113, v97
    v_mul_f32 v114, v114, v98
    v_mul_f32 v115, v115, v99
    v_exp_f32 v112, v112
    v_exp_f32 v113, v113
    v_exp_f32 v114, v114
    v_exp_f32 v115, v115
    v_add_f32 v112, 1.0, v112
    v_add_f32 v113, 1.0, v113
    v_add_f32 v114, 1.0, v114
    v_add_f32 v115, 1.0, v115
    v_rcp_f32 v112, v112
    v_rcp_f32 v113, v113
    v_rcp_f32 v114, v114
    v_rcp_f32 v115, v115
    v_mul_f32 v96, v96, v112
    v_mul_f32 v97, v97, v113
    v_mul_f32 v98, v98, v114
    v_mul_f32 v99, v99, v115
    v_cvt_pk_bf16_f32 v122, v96, v97
    v_cvt_pk_bf16_f32 v123, v98, v99
    buffer_store_dwordx2 v[122:123], v3, s[28:31], s43 offen
L_mlp1_0_kernel_fin:
L_mlp1_0_kernel_end:
    s_endpgm
.globl mlp2_1_kernel
.p2align 8
.type mlp2_1_kernel,@function
mlp2_1_kernel:
    s_mov_b32 s99, 1
    s_branch L_mlp2_body
.globl mlp2_0_kernel
.p2align 8
.type mlp2_0_kernel,@function
mlp2_0_kernel:
    s_mov_b32 s99, 0
L_mlp2_body:
    s_cmp_ge_u32 s2, 256
    s_cbranch_scc1 L_mlp2_0_kernel_end
    s_load_dwordx4 s[4:7], s[0:1], 64
    s_load_dwordx2 s[12:13], s[0:1], 96
    s_load_dwordx2 s[8:9], s[0:1], 80
    s_load_dwordx2 s[10:11], s[0:1], 8
    v_mov_b32 v40, v0
    v_lshrrev_b32 v1, 6, v0
    v_and_b32 v0, 63, v0
    v_readfirstlane_b32 s32, v1
    s_and_b32 s34, s2, 7
    s_lshr_b32 s33, s2, 3
    s_and_b32 s33, s33, 3
    s_lshl_b32 s33, s33, 3
    s_add_u32 s34, s34, s33
    s_lshr_b32 s33, s2, 5
    v_and_b32 v1, 15, v0
    v_lshrrev_b32 v2, 4, v0
    v_lshlrev_b32 v3, 4, v0
    s_cmp_ge_u32 s32, 10
    s_cbranch_scc1 L_mlp2_0_kernel_prod
    s_cmp_ge_u32 s32, 5
    s_cselect_b32 s53, 1, 0
    s_mul_i32 s52, s53, 5
    s_sub_u32 s52, s32, s52
    s_mul_i32 s41, s33, 5
    s_add_u32 s41, s41, s52
    s_mul_i32 s41, s41, 57344
    s_mul_i32 s42, s53, 28672
    s_add_u32 s41, s41, s42
    s_add_u32 s41, s41, 11534336
    s_waitcnt lgkmcnt(0)
    s_mov_b32 s28, s12
    s_and_b32 s29, s13, 0xffff
    s_mov_b32 s30, 0x10000000
    s_mov_b32 s31, 0x00020000
    buffer_load_dwordx4 v[48:51], v3, s[28:31], s41 offen
    buffer_load_dwordx4 v[52:55], v3, s[28:31], s41 offen offset:1024
    s_add_u32 s41, s41, 2048
    s_mov_b32 s24, s6
    s_and_b32 s25, s7, 0xffff
    s_mov_b32 s26, 0x1000
    s_mov_b32 s27, 0x00020000
    s_lshl_b32 s43, s34, 7
    s_lshl_b32 s44, s53, 6
    s_add_u32 s43, s43, s44
    v_lshlrev_b32 v10, 3, v2
    buffer_load_dwordx2 v[16:17], v10, s[24:27], s43 offen
    buffer_load_dwordx2 v[18:19], v10, s[24:27], s43 offen offset:32
    s_mul_i32 s43, s33, 5
    s_add_u32 s43, s43, s52
    s_lshl_b32 s43, s43, 16
    s_lshl_b32 s44, s34, 11
    s_add_u32 s43, s43, s44
    s_lshl_b32 s44, s53, 10
    s_add_u32 s43, s43, s44
    s_add_u32 s43, s43, 7340032
    buffer_load_dwordx4 v[20:23], v3, s[28:31], s43 offen
    buffer_load_dwordx4 v[56:59], v3, s[28:31], s41 offen
    buffer_load_dwordx4 v[60:63], v3, s[28:31], s41 offen offset:1024
    s_add_u32 s41, s41, 2048
    buffer_load_dwordx4 v[64:67], v3, s[28:31], s41 offen
    buffer_load_dwordx4 v[68:71], v3, s[28:31], s41 offen offset:1024
    s_add_u32 s41, s41, 2048
    buffer_load_dwordx4 v[72:75], v3, s[28:31], s41 offen
    buffer_load_dwordx4 v[76:79], v3, s[28:31], s41 offen offset:1024
    s_add_u32 s41, s41, 2048
    v_lshrrev_b32 v10, 2, v1
    v_lshl_add_u32 v10, v2, 2, v10
    v_lshrrev_b32 v11, 1, v10
    v_and_b32 v11, 3, v11
    v_and_b32 v12, 3, v1
    v_lshlrev_b32 v12, 3, v12
    v_lshl_add_u32 v12, v10, 7, v12
    s_mul_i32 s42, s53, 65536
    v_add_u32 v12, s42, v12
    v_xor_b32 v13, 0, v11
    v_lshl_add_u32 v6, v13, 5, v12
    v_xor_b32 v13, 1, v11
    v_lshl_add_u32 v7, v13, 5, v12
    v_xor_b32 v13, 2, v11
    v_lshl_add_u32 v8, v13, 5, v12
    v_xor_b32 v13, 3, v11
    v_lshl_add_u32 v9, v13, 5, v12
    v_mov_b32 v24, 0
    v_mov_b32 v25, 0
    v_mov_b32 v26, 0
    v_mov_b32 v27, 0
    v_mov_b32 v28, 0
    v_mov_b32 v29, 0
    v_mov_b32 v30, 0
    v_mov_b32 v31, 0
    v_mov_b32 v32, 0
    v_mov_b32 v33, 0
    v_mov_b32 v34, 0
    v_mov_b32 v35, 0
    v_mov_b32 v36, 0
    v_mov_b32 v37, 0
    v_mov_b32 v38, 0
    v_mov_b32 v39, 0
    s_mov_b32 s46, 0xffff0000
    s_barrier
    ds_read_b64_tr_b16 v[96:97], v6 offset:0
    ds_read_b64_tr_b16 v[98:99], v6 offset:2048
    ds_read_b64_tr_b16 v[100:101], v7 offset:0
    ds_read_b64_tr_b16 v[102:103], v7 offset:2048
    ds_read_b64_tr_b16 v[104:105], v8 offset:0
    ds_read_b64_tr_b16 v[106:107], v8 offset:2048
    ds_read_b64_tr_b16 v[108:109], v9 offset:0
    ds_read_b64_tr_b16 v[110:111], v9 offset:2048
    ds_read_b64_tr_b16 v[112:113], v6 offset:4096
    ds_read_b64_tr_b16 v[114:115], v6 offset:6144
    ds_read_b64_tr_b16 v[116:117], v7 offset:4096
    ds_read_b64_tr_b16 v[118:119], v7 offset:6144
    ds_read_b64_tr_b16 v[120:121], v8 offset:4096
    ds_read_b64_tr_b16 v[122:123], v8 offset:6144
    ds_read_b64_tr_b16 v[124:125], v9 offset:4096
    ds_read_b64_tr_b16 v[126:127], v9 offset:6144
    s_waitcnt vmcnt(9)
    s_waitcnt lgkmcnt(0)
    s_barrier
    v_mfma_f32_16x16x32_bf16 v[24:27], v[96:99], v[48:51], v[24:27]
    ds_read_b64_tr_b16 v[128:129], v6 offset:8192
    ds_read_b64_tr_b16 v[130:131], v6 offset:10240
    v_mfma_f32_16x16x32_bf16 v[28:31], v[100:103], v[48:51], v[28:31]
    ds_read_b64_tr_b16 v[132:133], v7 offset:8192
    ds_read_b64_tr_b16 v[134:135], v7 offset:10240
    v_mfma_f32_16x16x32_bf16 v[32:35], v[104:107], v[48:51], v[32:35]
    ds_read_b64_tr_b16 v[136:137], v8 offset:8192
    ds_read_b64_tr_b16 v[138:139], v8 offset:10240
    v_mfma_f32_16x16x32_bf16 v[36:39], v[108:111], v[48:51], v[36:39]
    ds_read_b64_tr_b16 v[140:141], v9 offset:8192
    ds_read_b64_tr_b16 v[142:143], v9 offset:10240
    v_mfma_f32_16x16x32_bf16 v[24:27], v[112:115], v[52:55], v[24:27]
    ds_read_b64_tr_b16 v[144:145], v6 offset:12288
    ds_read_b64_tr_b16 v[146:147], v6 offset:14336
    v_mfma_f32_16x16x32_bf16 v[28:31], v[116:119], v[52:55], v[28:31]
    ds_read_b64_tr_b16 v[148:149], v7 offset:12288
    ds_read_b64_tr_b16 v[150:151], v7 offset:14336
    v_mfma_f32_16x16x32_bf16 v[32:35], v[120:123], v[52:55], v[32:35]
    ds_read_b64_tr_b16 v[152:153], v8 offset:12288
    ds_read_b64_tr_b16 v[154:155], v8 offset:14336
    v_mfma_f32_16x16x32_bf16 v[36:39], v[124:127], v[52:55], v[36:39]
    ds_read_b64_tr_b16 v[156:157], v9 offset:12288
    ds_read_b64_tr_b16 v[158:159], v9 offset:14336
    buffer_load_dwordx4 v[48:51], v3, s[28:31], s41 offen
    buffer_load_dwordx4 v[52:55], v3, s[28:31], s41 offen offset:1024
    s_add_u32 s41, s41, 2048
    s_waitcnt lgkmcnt(0)
    s_barrier
    s_waitcnt vmcnt(6)
    v_mfma_f32_16x16x32_bf16 v[24:27], v[128:131], v[56:59], v[24:27]
    ds_read_b64_tr_b16 v[96:97], v6 offset:16384
    ds_read_b64_tr_b16 v[98:99], v6 offset:18432
    v_mfma_f32_16x16x32_bf16 v[28:31], v[132:135], v[56:59], v[28:31]
    ds_read_b64_tr_b16 v[100:101], v7 offset:16384
    ds_read_b64_tr_b16 v[102:103], v7 offset:18432
    v_mfma_f32_16x16x32_bf16 v[32:35], v[136:139], v[56:59], v[32:35]
    ds_read_b64_tr_b16 v[104:105], v8 offset:16384
    ds_read_b64_tr_b16 v[106:107], v8 offset:18432
    v_mfma_f32_16x16x32_bf16 v[36:39], v[140:143], v[56:59], v[36:39]
    ds_read_b64_tr_b16 v[108:109], v9 offset:16384
    ds_read_b64_tr_b16 v[110:111], v9 offset:18432
    v_mfma_f32_16x16x32_bf16 v[24:27], v[144:147], v[60:63], v[24:27]
    ds_read_b64_tr_b16 v[112:113], v6 offset:20480
    ds_read_b64_tr_b16 v[114:115], v6 offset:22528
    v_mfma_f32_16x16x32_bf16 v[28:31], v[148:151], v[60:63], v[28:31]
    ds_read_b64_tr_b16 v[116:117], v7 offset:20480
    ds_read_b64_tr_b16 v[118:119], v7 offset:22528
    v_mfma_f32_16x16x32_bf16 v[32:35], v[152:155], v[60:63], v[32:35]
    ds_read_b64_tr_b16 v[120:121], v8 offset:20480
    ds_read_b64_tr_b16 v[122:123], v8 offset:22528
    v_mfma_f32_16x16x32_bf16 v[36:39], v[156:159], v[60:63], v[36:39]
    ds_read_b64_tr_b16 v[124:125], v9 offset:20480
    ds_read_b64_tr_b16 v[126:127], v9 offset:22528
    buffer_load_dwordx4 v[56:59], v3, s[28:31], s41 offen
    buffer_load_dwordx4 v[60:63], v3, s[28:31], s41 offen offset:1024
    s_add_u32 s41, s41, 2048
    s_waitcnt lgkmcnt(0)
    s_barrier
    s_waitcnt vmcnt(6)
    v_mfma_f32_16x16x32_bf16 v[24:27], v[96:99], v[64:67], v[24:27]
    ds_read_b64_tr_b16 v[128:129], v6 offset:24576
    ds_read_b64_tr_b16 v[130:131], v6 offset:26624
    v_mfma_f32_16x16x32_bf16 v[28:31], v[100:103], v[64:67], v[28:31]
    ds_read_b64_tr_b16 v[132:133], v7 offset:24576
    ds_read_b64_tr_b16 v[134:135], v7 offset:26624
    v_mfma_f32_16x16x32_bf16 v[32:35], v[104:107], v[64:67], v[32:35]
    ds_read_b64_tr_b16 v[136:137], v8 offset:24576
    ds_read_b64_tr_b16 v[138:139], v8 offset:26624
    v_mfma_f32_16x16x32_bf16 v[36:39], v[108:111], v[64:67], v[36:39]
    ds_read_b64_tr_b16 v[140:141], v9 offset:24576
    ds_read_b64_tr_b16 v[142:143], v9 offset:26624
    v_mfma_f32_16x16x32_bf16 v[24:27], v[112:115], v[68:71], v[24:27]
    ds_read_b64_tr_b16 v[144:145], v6 offset:28672
    ds_read_b64_tr_b16 v[146:147], v6 offset:30720
    v_mfma_f32_16x16x32_bf16 v[28:31], v[116:119], v[68:71], v[28:31]
    ds_read_b64_tr_b16 v[148:149], v7 offset:28672
    ds_read_b64_tr_b16 v[150:151], v7 offset:30720
    v_mfma_f32_16x16x32_bf16 v[32:35], v[120:123], v[68:71], v[32:35]
    ds_read_b64_tr_b16 v[152:153], v8 offset:28672
    ds_read_b64_tr_b16 v[154:155], v8 offset:30720
    v_mfma_f32_16x16x32_bf16 v[36:39], v[124:127], v[68:71], v[36:39]
    ds_read_b64_tr_b16 v[156:157], v9 offset:28672
    ds_read_b64_tr_b16 v[158:159], v9 offset:30720
    buffer_load_dwordx4 v[64:67], v3, s[28:31], s41 offen
    buffer_load_dwordx4 v[68:71], v3, s[28:31], s41 offen offset:1024
    s_add_u32 s41, s41, 2048
    s_waitcnt lgkmcnt(0)
    s_barrier
    s_waitcnt vmcnt(6)
    v_mfma_f32_16x16x32_bf16 v[24:27], v[128:131], v[72:75], v[24:27]
    ds_read_b64_tr_b16 v[96:97], v6 offset:32768
    ds_read_b64_tr_b16 v[98:99], v6 offset:34816
    v_mfma_f32_16x16x32_bf16 v[28:31], v[132:135], v[72:75], v[28:31]
    ds_read_b64_tr_b16 v[100:101], v7 offset:32768
    ds_read_b64_tr_b16 v[102:103], v7 offset:34816
    v_mfma_f32_16x16x32_bf16 v[32:35], v[136:139], v[72:75], v[32:35]
    ds_read_b64_tr_b16 v[104:105], v8 offset:32768
    ds_read_b64_tr_b16 v[106:107], v8 offset:34816
    v_mfma_f32_16x16x32_bf16 v[36:39], v[140:143], v[72:75], v[36:39]
    ds_read_b64_tr_b16 v[108:109], v9 offset:32768
    ds_read_b64_tr_b16 v[110:111], v9 offset:34816
    v_mfma_f32_16x16x32_bf16 v[24:27], v[144:147], v[76:79], v[24:27]
    ds_read_b64_tr_b16 v[112:113], v6 offset:36864
    ds_read_b64_tr_b16 v[114:115], v6 offset:38912
    v_mfma_f32_16x16x32_bf16 v[28:31], v[148:151], v[76:79], v[28:31]
    ds_read_b64_tr_b16 v[116:117], v7 offset:36864
    ds_read_b64_tr_b16 v[118:119], v7 offset:38912
    v_mfma_f32_16x16x32_bf16 v[32:35], v[152:155], v[76:79], v[32:35]
    ds_read_b64_tr_b16 v[120:121], v8 offset:36864
    ds_read_b64_tr_b16 v[122:123], v8 offset:38912
    v_mfma_f32_16x16x32_bf16 v[36:39], v[156:159], v[76:79], v[36:39]
    ds_read_b64_tr_b16 v[124:125], v9 offset:36864
    ds_read_b64_tr_b16 v[126:127], v9 offset:38912
    buffer_load_dwordx4 v[72:75], v3, s[28:31], s41 offen
    buffer_load_dwordx4 v[76:79], v3, s[28:31], s41 offen offset:1024
    s_add_u32 s41, s41, 2048
    s_waitcnt lgkmcnt(0)
    s_barrier
    s_waitcnt vmcnt(6)
    v_mfma_f32_16x16x32_bf16 v[24:27], v[96:99], v[48:51], v[24:27]
    ds_read_b64_tr_b16 v[128:129], v6 offset:40960
    ds_read_b64_tr_b16 v[130:131], v6 offset:43008
    v_mfma_f32_16x16x32_bf16 v[28:31], v[100:103], v[48:51], v[28:31]
    ds_read_b64_tr_b16 v[132:133], v7 offset:40960
    ds_read_b64_tr_b16 v[134:135], v7 offset:43008
    v_mfma_f32_16x16x32_bf16 v[32:35], v[104:107], v[48:51], v[32:35]
    ds_read_b64_tr_b16 v[136:137], v8 offset:40960
    ds_read_b64_tr_b16 v[138:139], v8 offset:43008
    v_mfma_f32_16x16x32_bf16 v[36:39], v[108:111], v[48:51], v[36:39]
    ds_read_b64_tr_b16 v[140:141], v9 offset:40960
    ds_read_b64_tr_b16 v[142:143], v9 offset:43008
    v_mfma_f32_16x16x32_bf16 v[24:27], v[112:115], v[52:55], v[24:27]
    ds_read_b64_tr_b16 v[144:145], v6 offset:45056
    ds_read_b64_tr_b16 v[146:147], v6 offset:47104
    v_mfma_f32_16x16x32_bf16 v[28:31], v[116:119], v[52:55], v[28:31]
    ds_read_b64_tr_b16 v[148:149], v7 offset:45056
    ds_read_b64_tr_b16 v[150:151], v7 offset:47104
    v_mfma_f32_16x16x32_bf16 v[32:35], v[120:123], v[52:55], v[32:35]
    ds_read_b64_tr_b16 v[152:153], v8 offset:45056
    ds_read_b64_tr_b16 v[154:155], v8 offset:47104
    v_mfma_f32_16x16x32_bf16 v[36:39], v[124:127], v[52:55], v[36:39]
    ds_read_b64_tr_b16 v[156:157], v9 offset:45056
    ds_read_b64_tr_b16 v[158:159], v9 offset:47104
    buffer_load_dwordx4 v[48:51], v3, s[28:31], s41 offen
    buffer_load_dwordx4 v[52:55], v3, s[28:31], s41 offen offset:1024
    s_add_u32 s41, s41, 2048
    s_waitcnt lgkmcnt(0)
    s_barrier
    s_waitcnt vmcnt(6)
    v_mfma_f32_16x16x32_bf16 v[24:27], v[128:131], v[56:59], v[24:27]
    ds_read_b64_tr_b16 v[96:97], v6 offset:49152
    ds_read_b64_tr_b16 v[98:99], v6 offset:51200
    v_mfma_f32_16x16x32_bf16 v[28:31], v[132:135], v[56:59], v[28:31]
    ds_read_b64_tr_b16 v[100:101], v7 offset:49152
    ds_read_b64_tr_b16 v[102:103], v7 offset:51200
    v_mfma_f32_16x16x32_bf16 v[32:35], v[136:139], v[56:59], v[32:35]
    ds_read_b64_tr_b16 v[104:105], v8 offset:49152
    ds_read_b64_tr_b16 v[106:107], v8 offset:51200
    v_mfma_f32_16x16x32_bf16 v[36:39], v[140:143], v[56:59], v[36:39]
    ds_read_b64_tr_b16 v[108:109], v9 offset:49152
    ds_read_b64_tr_b16 v[110:111], v9 offset:51200
    v_mfma_f32_16x16x32_bf16 v[24:27], v[144:147], v[60:63], v[24:27]
    ds_read_b64_tr_b16 v[112:113], v6 offset:53248
    ds_read_b64_tr_b16 v[114:115], v6 offset:55296
    v_mfma_f32_16x16x32_bf16 v[28:31], v[148:151], v[60:63], v[28:31]
    ds_read_b64_tr_b16 v[116:117], v7 offset:53248
    ds_read_b64_tr_b16 v[118:119], v7 offset:55296
    v_mfma_f32_16x16x32_bf16 v[32:35], v[152:155], v[60:63], v[32:35]
    ds_read_b64_tr_b16 v[120:121], v8 offset:53248
    ds_read_b64_tr_b16 v[122:123], v8 offset:55296
    v_mfma_f32_16x16x32_bf16 v[36:39], v[156:159], v[60:63], v[36:39]
    ds_read_b64_tr_b16 v[124:125], v9 offset:53248
    ds_read_b64_tr_b16 v[126:127], v9 offset:55296
    buffer_load_dwordx4 v[56:59], v3, s[28:31], s41 offen
    buffer_load_dwordx4 v[60:63], v3, s[28:31], s41 offen offset:1024
    s_add_u32 s41, s41, 2048
    s_waitcnt lgkmcnt(0)
    s_barrier
    s_waitcnt vmcnt(6)
    v_mfma_f32_16x16x32_bf16 v[24:27], v[96:99], v[64:67], v[24:27]
    ds_read_b64_tr_b16 v[128:129], v6 offset:57344
    ds_read_b64_tr_b16 v[130:131], v6 offset:59392
    v_mfma_f32_16x16x32_bf16 v[28:31], v[100:103], v[64:67], v[28:31]
    ds_read_b64_tr_b16 v[132:133], v7 offset:57344
    ds_read_b64_tr_b16 v[134:135], v7 offset:59392
    v_mfma_f32_16x16x32_bf16 v[32:35], v[104:107], v[64:67], v[32:35]
    ds_read_b64_tr_b16 v[136:137], v8 offset:57344
    ds_read_b64_tr_b16 v[138:139], v8 offset:59392
    v_mfma_f32_16x16x32_bf16 v[36:39], v[108:111], v[64:67], v[36:39]
    ds_read_b64_tr_b16 v[140:141], v9 offset:57344
    ds_read_b64_tr_b16 v[142:143], v9 offset:59392
    v_mfma_f32_16x16x32_bf16 v[24:27], v[112:115], v[68:71], v[24:27]
    ds_read_b64_tr_b16 v[144:145], v6 offset:61440
    ds_read_b64_tr_b16 v[146:147], v6 offset:63488
    v_mfma_f32_16x16x32_bf16 v[28:31], v[116:119], v[68:71], v[28:31]
    ds_read_b64_tr_b16 v[148:149], v7 offset:61440
    ds_read_b64_tr_b16 v[150:151], v7 offset:63488
    v_mfma_f32_16x16x32_bf16 v[32:35], v[120:123], v[68:71], v[32:35]
    ds_read_b64_tr_b16 v[152:153], v8 offset:61440
    ds_read_b64_tr_b16 v[154:155], v8 offset:63488
    v_mfma_f32_16x16x32_bf16 v[36:39], v[124:127], v[68:71], v[36:39]
    ds_read_b64_tr_b16 v[156:157], v9 offset:61440
    ds_read_b64_tr_b16 v[158:159], v9 offset:63488
    buffer_load_dwordx4 v[64:67], v3, s[28:31], s41 offen
    buffer_load_dwordx4 v[68:71], v3, s[28:31], s41 offen offset:1024
    s_add_u32 s41, s41, 2048
    s_waitcnt lgkmcnt(0)
    s_barrier
    s_waitcnt vmcnt(6)
    v_mfma_f32_16x16x32_bf16 v[24:27], v[128:131], v[72:75], v[24:27]
    ds_read_b64_tr_b16 v[96:97], v6 offset:0
    ds_read_b64_tr_b16 v[98:99], v6 offset:2048
    v_mfma_f32_16x16x32_bf16 v[28:31], v[132:135], v[72:75], v[28:31]
    ds_read_b64_tr_b16 v[100:101], v7 offset:0
    ds_read_b64_tr_b16 v[102:103], v7 offset:2048
    v_mfma_f32_16x16x32_bf16 v[32:35], v[136:139], v[72:75], v[32:35]
    ds_read_b64_tr_b16 v[104:105], v8 offset:0
    ds_read_b64_tr_b16 v[106:107], v8 offset:2048
    v_mfma_f32_16x16x32_bf16 v[36:39], v[140:143], v[72:75], v[36:39]
    ds_read_b64_tr_b16 v[108:109], v9 offset:0
    ds_read_b64_tr_b16 v[110:111], v9 offset:2048
    v_mfma_f32_16x16x32_bf16 v[24:27], v[144:147], v[76:79], v[24:27]
    ds_read_b64_tr_b16 v[112:113], v6 offset:4096
    ds_read_b64_tr_b16 v[114:115], v6 offset:6144
    v_mfma_f32_16x16x32_bf16 v[28:31], v[148:151], v[76:79], v[28:31]
    ds_read_b64_tr_b16 v[116:117], v7 offset:4096
    ds_read_b64_tr_b16 v[118:119], v7 offset:6144
    v_mfma_f32_16x16x32_bf16 v[32:35], v[152:155], v[76:79], v[32:35]
    ds_read_b64_tr_b16 v[120:121], v8 offset:4096
    ds_read_b64_tr_b16 v[122:123], v8 offset:6144
    v_mfma_f32_16x16x32_bf16 v[36:39], v[156:159], v[76:79], v[36:39]
    ds_read_b64_tr_b16 v[124:125], v9 offset:4096
    ds_read_b64_tr_b16 v[126:127], v9 offset:6144
    buffer_load_dwordx4 v[72:75], v3, s[28:31], s41 offen
    buffer_load_dwordx4 v[76:79], v3, s[28:31], s41 offen offset:1024
    s_add_u32 s41, s41, 2048
    s_waitcnt lgkmcnt(0)
    s_barrier
    s_waitcnt vmcnt(6)
    v_mfma_f32_16x16x32_bf16 v[24:27], v[96:99], v[48:51], v[24:27]
    ds_read_b64_tr_b16 v[128:129], v6 offset:8192
    ds_read_b64_tr_b16 v[130:131], v6 offset:10240
    v_mfma_f32_16x16x32_bf16 v[28:31], v[100:103], v[48:51], v[28:31]
    ds_read_b64_tr_b16 v[132:133], v7 offset:8192
    ds_read_b64_tr_b16 v[134:135], v7 offset:10240
    v_mfma_f32_16x16x32_bf16 v[32:35], v[104:107], v[48:51], v[32:35]
    ds_read_b64_tr_b16 v[136:137], v8 offset:8192
    ds_read_b64_tr_b16 v[138:139], v8 offset:10240
    v_mfma_f32_16x16x32_bf16 v[36:39], v[108:111], v[48:51], v[36:39]
    ds_read_b64_tr_b16 v[140:141], v9 offset:8192
    ds_read_b64_tr_b16 v[142:143], v9 offset:10240
    v_mfma_f32_16x16x32_bf16 v[24:27], v[112:115], v[52:55], v[24:27]
    ds_read_b64_tr_b16 v[144:145], v6 offset:12288
    ds_read_b64_tr_b16 v[146:147], v6 offset:14336
    v_mfma_f32_16x16x32_bf16 v[28:31], v[116:119], v[52:55], v[28:31]
    ds_read_b64_tr_b16 v[148:149], v7 offset:12288
    ds_read_b64_tr_b16 v[150:151], v7 offset:14336
    v_mfma_f32_16x16x32_bf16 v[32:35], v[120:123], v[52:55], v[32:35]
    ds_read_b64_tr_b16 v[152:153], v8 offset:12288
    ds_read_b64_tr_b16 v[154:155], v8 offset:14336
    v_mfma_f32_16x16x32_bf16 v[36:39], v[124:127], v[52:55], v[36:39]
    ds_read_b64_tr_b16 v[156:157], v9 offset:12288
    ds_read_b64_tr_b16 v[158:159], v9 offset:14336
    buffer_load_dwordx4 v[48:51], v3, s[28:31], s41 offen
    buffer_load_dwordx4 v[52:55], v3, s[28:31], s41 offen offset:1024
    s_add_u32 s41, s41, 2048
    s_waitcnt lgkmcnt(0)
    s_barrier
    s_waitcnt vmcnt(6)
    v_mfma_f32_16x16x32_bf16 v[24:27], v[128:131], v[56:59], v[24:27]
    ds_read_b64_tr_b16 v[96:97], v6 offset:16384
    ds_read_b64_tr_b16 v[98:99], v6 offset:18432
    v_mfma_f32_16x16x32_bf16 v[28:31], v[132:135], v[56:59], v[28:31]
    ds_read_b64_tr_b16 v[100:101], v7 offset:16384
    ds_read_b64_tr_b16 v[102:103], v7 offset:18432
    v_mfma_f32_16x16x32_bf16 v[32:35], v[136:139], v[56:59], v[32:35]
    ds_read_b64_tr_b16 v[104:105], v8 offset:16384
    ds_read_b64_tr_b16 v[106:107], v8 offset:18432
    v_mfma_f32_16x16x32_bf16 v[36:39], v[140:143], v[56:59], v[36:39]
    ds_read_b64_tr_b16 v[108:109], v9 offset:16384
    ds_read_b64_tr_b16 v[110:111], v9 offset:18432
    v_mfma_f32_16x16x32_bf16 v[24:27], v[144:147], v[60:63], v[24:27]
    ds_read_b64_tr_b16 v[112:113], v6 offset:20480
    ds_read_b64_tr_b16 v[114:115], v6 offset:22528
    v_mfma_f32_16x16x32_bf16 v[28:31], v[148:151], v[60:63], v[28:31]
    ds_read_b64_tr_b16 v[116:117], v7 offset:20480
    ds_read_b64_tr_b16 v[118:119], v7 offset:22528
    v_mfma_f32_16x16x32_bf16 v[32:35], v[152:155], v[60:63], v[32:35]
    ds_read_b64_tr_b16 v[120:121], v8 offset:20480
    ds_read_b64_tr_b16 v[122:123], v8 offset:22528
    v_mfma_f32_16x16x32_bf16 v[36:39], v[156:159], v[60:63], v[36:39]
    ds_read_b64_tr_b16 v[124:125], v9 offset:20480
    ds_read_b64_tr_b16 v[126:127], v9 offset:22528
    buffer_load_dwordx4 v[56:59], v3, s[28:31], s41 offen
    buffer_load_dwordx4 v[60:63], v3, s[28:31], s41 offen offset:1024
    s_add_u32 s41, s41, 2048
    s_waitcnt lgkmcnt(0)
    s_barrier
    s_waitcnt vmcnt(6)
    v_mfma_f32_16x16x32_bf16 v[24:27], v[96:99], v[64:67], v[24:27]
    ds_read_b64_tr_b16 v[128:129], v6 offset:24576
    ds_read_b64_tr_b16 v[130:131], v6 offset:26624
    v_mfma_f32_16x16x32_bf16 v[28:31], v[100:103], v[64:67], v[28:31]
    ds_read_b64_tr_b16 v[132:133], v7 offset:24576
    ds_read_b64_tr_b16 v[134:135], v7 offset:26624
    v_mfma_f32_16x16x32_bf16 v[32:35], v[104:107], v[64:67], v[32:35]
    ds_read_b64_tr_b16 v[136:137], v8 offset:24576
    ds_read_b64_tr_b16 v[138:139], v8 offset:26624
    v_mfma_f32_16x16x32_bf16 v[36:39], v[108:111], v[64:67], v[36:39]
    ds_read_b64_tr_b16 v[140:141], v9 offset:24576
    ds_read_b64_tr_b16 v[142:143], v9 offset:26624
    v_mfma_f32_16x16x32_bf16 v[24:27], v[112:115], v[68:71], v[24:27]
    ds_read_b64_tr_b16 v[144:145], v6 offset:28672
    ds_read_b64_tr_b16 v[146:147], v6 offset:30720
    v_mfma_f32_16x16x32_bf16 v[28:31], v[116:119], v[68:71], v[28:31]
    ds_read_b64_tr_b16 v[148:149], v7 offset:28672
    ds_read_b64_tr_b16 v[150:151], v7 offset:30720
    v_mfma_f32_16x16x32_bf16 v[32:35], v[120:123], v[68:71], v[32:35]
    ds_read_b64_tr_b16 v[152:153], v8 offset:28672
    ds_read_b64_tr_b16 v[154:155], v8 offset:30720
    v_mfma_f32_16x16x32_bf16 v[36:39], v[124:127], v[68:71], v[36:39]
    ds_read_b64_tr_b16 v[156:157], v9 offset:28672
    ds_read_b64_tr_b16 v[158:159], v9 offset:30720
    s_waitcnt lgkmcnt(0)
    s_barrier
    s_waitcnt vmcnt(4)
    v_mfma_f32_16x16x32_bf16 v[24:27], v[128:131], v[72:75], v[24:27]
    ds_read_b64_tr_b16 v[96:97], v6 offset:32768
    ds_read_b64_tr_b16 v[98:99], v6 offset:34816
    v_mfma_f32_16x16x32_bf16 v[28:31], v[132:135], v[72:75], v[28:31]
    ds_read_b64_tr_b16 v[100:101], v7 offset:32768
    ds_read_b64_tr_b16 v[102:103], v7 offset:34816
    v_mfma_f32_16x16x32_bf16 v[32:35], v[136:139], v[72:75], v[32:35]
    ds_read_b64_tr_b16 v[104:105], v8 offset:32768
    ds_read_b64_tr_b16 v[106:107], v8 offset:34816
    v_mfma_f32_16x16x32_bf16 v[36:39], v[140:143], v[72:75], v[36:39]
    ds_read_b64_tr_b16 v[108:109], v9 offset:32768
    ds_read_b64_tr_b16 v[110:111], v9 offset:34816
    v_mfma_f32_16x16x32_bf16 v[24:27], v[144:147], v[76:79], v[24:27]
    ds_read_b64_tr_b16 v[112:113], v6 offset:36864
    ds_read_b64_tr_b16 v[114:115], v6 offset:38912
    v_mfma_f32_16x16x32_bf16 v[28:31], v[148:151], v[76:79], v[28:31]
    ds_read_b64_tr_b16 v[116:117], v7 offset:36864
    ds_read_b64_tr_b16 v[118:119], v7 offset:38912
    v_mfma_f32_16x16x32_bf16 v[32:35], v[152:155], v[76:79], v[32:35]
    ds_read_b64_tr_b16 v[120:121], v8 offset:36864
    ds_read_b64_tr_b16 v[122:123], v8 offset:38912
    v_mfma_f32_16x16x32_bf16 v[36:39], v[156:159], v[76:79], v[36:39]
    ds_read_b64_tr_b16 v[124:125], v9 offset:36864
    ds_read_b64_tr_b16 v[126:127], v9 offset:38912
    s_waitcnt lgkmcnt(0)
    s_barrier
    s_waitcnt vmcnt(2)
    v_mfma_f32_16x16x32_bf16 v[24:27], v[96:99], v[48:51], v[24:27]
    ds_read_b64_tr_b16 v[128:129], v6 offset:40960
    ds_read_b64_tr_b16 v[130:131], v6 offset:43008
    v_mfma_f32_16x16x32_bf16 v[28:31], v[100:103], v[48:51], v[28:31]
    ds_read_b64_tr_b16 v[132:133], v7 offset:40960
    ds_read_b64_tr_b16 v[134:135], v7 offset:43008
    v_mfma_f32_16x16x32_bf16 v[32:35], v[104:107], v[48:51], v[32:35]
    ds_read_b64_tr_b16 v[136:137], v8 offset:40960
    ds_read_b64_tr_b16 v[138:139], v8 offset:43008
    v_mfma_f32_16x16x32_bf16 v[36:39], v[108:111], v[48:51], v[36:39]
    ds_read_b64_tr_b16 v[140:141], v9 offset:40960
    ds_read_b64_tr_b16 v[142:143], v9 offset:43008
    v_mfma_f32_16x16x32_bf16 v[24:27], v[112:115], v[52:55], v[24:27]
    ds_read_b64_tr_b16 v[144:145], v6 offset:45056
    ds_read_b64_tr_b16 v[146:147], v6 offset:47104
    v_mfma_f32_16x16x32_bf16 v[28:31], v[116:119], v[52:55], v[28:31]
    ds_read_b64_tr_b16 v[148:149], v7 offset:45056
    ds_read_b64_tr_b16 v[150:151], v7 offset:47104
    v_mfma_f32_16x16x32_bf16 v[32:35], v[120:123], v[52:55], v[32:35]
    ds_read_b64_tr_b16 v[152:153], v8 offset:45056
    ds_read_b64_tr_b16 v[154:155], v8 offset:47104
    v_mfma_f32_16x16x32_bf16 v[36:39], v[124:127], v[52:55], v[36:39]
    ds_read_b64_tr_b16 v[156:157], v9 offset:45056
    ds_read_b64_tr_b16 v[158:159], v9 offset:47104
    s_waitcnt lgkmcnt(0)
    s_waitcnt vmcnt(0)
    v_mfma_f32_16x16x32_bf16 v[24:27], v[128:131], v[56:59], v[24:27]
    v_mfma_f32_16x16x32_bf16 v[28:31], v[132:135], v[56:59], v[28:31]
    v_mfma_f32_16x16x32_bf16 v[32:35], v[136:139], v[56:59], v[32:35]
    v_mfma_f32_16x16x32_bf16 v[36:39], v[140:143], v[56:59], v[36:39]
    v_mfma_f32_16x16x32_bf16 v[24:27], v[144:147], v[60:63], v[24:27]
    v_mfma_f32_16x16x32_bf16 v[28:31], v[148:151], v[60:63], v[28:31]
    v_mfma_f32_16x16x32_bf16 v[32:35], v[152:155], v[60:63], v[32:35]
    v_mfma_f32_16x16x32_bf16 v[36:39], v[156:159], v[60:63], v[36:39]
    s_nop 7
    s_barrier
    s_lshl_b32 s43, s32, 11
    v_add_u32 v10, s43, v3
    s_cmp_eq_u32 s53, 0
    s_cbranch_scc1 L_mlp2_0_kernel_x0
    ds_write_b128 v10, v[24:27]
    ds_write_b128 v10, v[28:31] offset:1024
    v_mov_b32 v24, v32
    v_mov_b32 v25, v33
    v_mov_b32 v26, v34
    v_mov_b32 v27, v35
    v_mov_b32 v28, v36
    v_mov_b32 v29, v37
    v_mov_b32 v30, v38
    v_mov_b32 v31, v39
    s_sub_u32 s43, s43, 10240
    s_branch L_mlp2_0_kernel_x1
L_mlp2_0_kernel_x0:
    ds_write_b128 v10, v[32:35]
    ds_write_b128 v10, v[36:39] offset:1024
    s_add_u32 s43, s43, 10240
L_mlp2_0_kernel_x1:
    v_add_u32 v10, s43, v3
    s_waitcnt lgkmcnt(0)
    s_barrier
    ds_read_b128 v[48:51], v10
    ds_read_b128 v[52:55], v10 offset:1024
    v_lshlrev_b32 v56, 16, v16
    v_and_b32 v57, s46, v16
    v_lshlrev_b32 v58, 16, v17
    v_and_b32 v59, s46, v17
    v_lshlrev_b32 v60, 16, v18
    v_and_b32 v61, s46, v18
    v_lshlrev_b32 v62, 16, v19
    v_and_b32 v63, s46, v19
    s_waitcnt lgkmcnt(0)
    v_add_f32 v24, v24, v48
    v_add_f32 v24, v24, v56
    v_add_f32 v25, v25, v49
    v_add_f32 v25, v25, v57
    v_add_f32 v26, v26, v50
    v_add_f32 v26, v26, v58
    v_add_f32 v27, v27, v51
    v_add_f32 v27, v27, v59
    v_add_f32 v28, v28, v52
    v_add_f32 v28, v28, v60
    v_add_f32 v29, v29, v53
    v_add_f32 v29, v29, v61
    v_add_f32 v30, v30, v54
    v_add_f32 v30, v30, v62
    v_add_f32 v31, v31, v55
    v_add_f32 v31, v31, v63
    s_mul_i32 s43, s53, 5120
    s_lshl_b32 s44, s52, 5
    s_add_u32 s43, s43, s44
    s_add_u32 s43, s43, 32768
    v_mul_u32_u24 v10, 640, v2
    v_lshl_add_u32 v10, v1, 1, v10
    v_add_u32 v10, s43, v10
    v_lshlrev_b32 v64, 16, v20
    v_and_b32 v65, s46, v20
    v_add_f32 v64, v64, v24
    v_add_f32 v65, v65, v25
    v_cvt_pk_bf16_f32 v66, v64, v65
    ds_write_b16 v10, v66 offset:0
    ds_write_b16_d16_hi v10, v66 offset:160
    v_lshlrev_b32 v64, 16, v21
    v_and_b32 v65, s46, v21
    v_add_f32 v64, v64, v26
    v_add_f32 v65, v65, v27
    v_cvt_pk_bf16_f32 v67, v64, v65
    ds_write_b16 v10, v67 offset:320
    ds_write_b16_d16_hi v10, v67 offset:480
    v_lshlrev_b32 v64, 16, v22
    v_and_b32 v65, s46, v22
    v_add_f32 v64, v64, v28
    v_add_f32 v65, v65, v29
    v_cvt_pk_bf16_f32 v66, v64, v65
    ds_write_b16 v10, v66 offset:2560
    ds_write_b16_d16_hi v10, v66 offset:2720
    v_lshlrev_b32 v64, 16, v23
    v_and_b32 v65, s46, v23
    v_add_f32 v64, v64, v30
    v_add_f32 v65, v65, v31
    v_cvt_pk_bf16_f32 v67, v64, v65
    ds_write_b16 v10, v67 offset:2880
    ds_write_b16_d16_hi v10, v67 offset:3040
    s_add_u32 s14, s12, 0xe00000
    s_addc_u32 s15, s13, 0
    s_cmp_eq_u32 s99, 0
    s_cselect_b32 s8, s14, s8
    s_cselect_b32 s9, s15, s9
    s_mov_b32 s16, s8
    s_and_b32 s17, s9, 0xffff
    s_mov_b32 s18, 0x280000
    s_mov_b32 s19, 0x00020000
    s_mul_i32 s44, s34, 81920
    s_mul_i32 s45, s33, 160
    s_add_u32 s44, s44, s45
    s_mov_b32 s47, 6554
    s_movk_i32 s48, 1280
    v_mul_lo_u32 v13, v40, s47
    v_lshrrev_b32 v13, 16, v13
    v_mul_u32_u24 v14, 10, v13
    v_sub_u32 v14, v40, v14
    v_mul_lo_u32 v13, v13, s48
    v_lshl_add_u32 v13, v14, 4, v13
    v_lshlrev_b32 v11, 4, v40
    s_waitcnt lgkmcnt(0)
    s_barrier
    ds_read_b128 v[72:75], v11 offset:32768
    s_waitcnt lgkmcnt(0)
    buffer_store_dwordx4 v[72:75], v13, s[16:19], s44 offen
    s_branch L_mlp2_0_kernel_fin
L_mlp2_0_kernel_prod:
    s_sub_u32 s53, s32, 10
    v_lshrrev_b32 v10, 3, v0
    v_lshrrev_b32 v11, 1, v10
    v_and_b32 v11, 3, v11
    v_lshlrev_b32 v11, 1, v11
    v_and_b32 v12, 7, v0
    v_xor_b32 v12, v12, v11
    s_movk_i32 s38, 4096
    v_mul_lo_u32 v5, v10, s38
    v_lshl_add_u32 v44, v12, 4, v5
    v_add_u32 v45, 31744, v44
    v_add_u32 v46, 63488, v44
    v_add_u32 v47, 95232, v44
    s_mul_i32 s40, s53, 3670016
    s_lshl_b32 s41, s34, 7
    s_add_u32 s40, s40, s41
    s_mul_i32 s42, s53, 65536
    s_waitcnt lgkmcnt(0)
    s_mov_b32 s20, s4
    s_and_b32 s21, s5, 0xffff
    s_mov_b32 s22, 0x6c0000
    s_mov_b32 s23, 0x00020000
    s_mov_b32 s28, s12
    s_and_b32 s29, s13, 0xffff
    s_mov_b32 s30, 0x10000000
    s_mov_b32 s31, 0x00020000
    s_add_u32 s44, s42, 0
    s_mov_b32 m0, s44
    s_nop 0
    buffer_load_dwordx4 v44, s[20:23], s40 offen offset:0 lds
    buffer_load_dwordx4 v45, s[20:23], s40 offen offset:1024 lds
    buffer_load_dwordx4 v46, s[20:23], s40 offen offset:2048 lds
    buffer_load_dwordx4 v47, s[20:23], s40 offen offset:3072 lds
    s_add_u32 s40, s40, 131072
    s_add_u32 s44, s42, 4096
    s_mov_b32 m0, s44
    s_nop 0
    buffer_load_dwordx4 v44, s[20:23], s40 offen offset:0 lds
    buffer_load_dwordx4 v45, s[20:23], s40 offen offset:1024 lds
    buffer_load_dwordx4 v46, s[20:23], s40 offen offset:2048 lds
    buffer_load_dwordx4 v47, s[20:23], s40 offen offset:3072 lds
    s_add_u32 s40, s40, 131072
    s_add_u32 s44, s42, 8192
    s_mov_b32 m0, s44
    s_nop 0
    buffer_load_dwordx4 v44, s[20:23], s40 offen offset:0 lds
    buffer_load_dwordx4 v45, s[20:23], s40 offen offset:1024 lds
    buffer_load_dwordx4 v46, s[20:23], s40 offen offset:2048 lds
    buffer_load_dwordx4 v47, s[20:23], s40 offen offset:3072 lds
    s_add_u32 s40, s40, 131072
    s_add_u32 s44, s42, 12288
    s_mov_b32 m0, s44
    s_nop 0
    buffer_load_dwordx4 v44, s[20:23], s40 offen offset:0 lds
    buffer_load_dwordx4 v45, s[20:23], s40 offen offset:1024 lds
    buffer_load_dwordx4 v46, s[20:23], s40 offen offset:2048 lds
    buffer_load_dwordx4 v47, s[20:23], s40 offen offset:3072 lds
    s_add_u32 s40, s40, 131072
    s_add_u32 s44, s42, 16384
    s_mov_b32 m0, s44
    s_nop 0
    buffer_load_dwordx4 v44, s[20:23], s40 offen offset:0 lds
    buffer_load_dwordx4 v45, s[20:23], s40 offen offset:1024 lds
    buffer_load_dwordx4 v46, s[20:23], s40 offen offset:2048 lds
    buffer_load_dwordx4 v47, s[20:23], s40 offen offset:3072 lds
    s_add_u32 s40, s40, 131072
    s_add_u32 s44, s42, 20480
    s_mov_b32 m0, s44
    s_nop 0
    buffer_load_dwordx4 v44, s[20:23], s40 offen offset:0 lds
    buffer_load_dwordx4 v45, s[20:23], s40 offen offset:1024 lds
    buffer_load_dwordx4 v46, s[20:23], s40 offen offset:2048 lds
    buffer_load_dwordx4 v47, s[20:23], s40 offen offset:3072 lds
    s_add_u32 s40, s40, 131072
    s_waitcnt vmcnt(16)
    s_barrier
    s_add_u32 s44, s42, 24576
    s_mov_b32 m0, s44
    s_nop 0
    buffer_load_dwordx4 v44, s[20:23], s40 offen offset:0 lds
    buffer_load_dwordx4 v45, s[20:23], s40 offen offset:1024 lds
    buffer_load_dwordx4 v46, s[20:23], s40 offen offset:2048 lds
    buffer_load_dwordx4 v47, s[20:23], s40 offen offset:3072 lds
    s_add_u32 s40, s40, 131072
    s_add_u32 s44, s42, 28672
    s_mov_b32 m0, s44
    s_nop 0
    buffer_load_dwordx4 v44, s[20:23], s40 offen offset:0 lds
    buffer_load_dwordx4 v45, s[20:23], s40 offen offset:1024 lds
    buffer_load_dwordx4 v46, s[20:23], s40 offen offset:2048 lds
    buffer_load_dwordx4 v47, s[20:23], s40 offen offset:3072 lds
    s_add_u32 s40, s40, 131072
    s_add_u32 s44, s42, 32768
    s_mov_b32 m0, s44
    s_nop 0
    buffer_load_dwordx4 v44, s[20:23], s40 offen offset:0 lds
    buffer_load_dwordx4 v45, s[20:23], s40 offen offset:1024 lds
    buffer_load_dwordx4 v46, s[20:23], s40 offen offset:2048 lds
    buffer_load_dwordx4 v47, s[20:23], s40 offen offset:3072 lds
    s_add_u32 s40, s40, 131072
    s_add_u32 s44, s42, 36864
    s_mov_b32 m0, s44
    s_nop 0
    buffer_load_dwordx4 v44, s[20:23], s40 offen offset:0 lds
    buffer_load_dwordx4 v45, s[20:23], s40 offen offset:1024 lds
    buffer_load_dwordx4 v46, s[20:23], s40 offen offset:2048 lds
    buffer_load_dwordx4 v47, s[20:23], s40 offen offset:3072 lds
    s_add_u32 s40, s40, 131072
    s_waitcnt vmcnt(24)
    s_barrier
    s_add_u32 s44, s42, 40960
    s_mov_b32 m0, s44
    s_nop 0
    buffer_load_dwordx4 v44, s[20:23], s40 offen offset:0 lds
    buffer_load_dwordx4 v45, s[20:23], s40 offen offset:1024 lds
    buffer_load_dwordx4 v46, s[20:23], s40 offen offset:2048 lds
    buffer_load_dwordx4 v47, s[20:23], s40 offen offset:3072 lds
    s_add_u32 s40, s40, 131072
    s_add_u32 s44, s42, 45056
    s_mov_b32 m0, s44
    s_nop 0
    buffer_load_dwordx4 v44, s[20:23], s40 offen offset:0 lds
    buffer_load_dwordx4 v45, s[20:23], s40 offen offset:1024 lds
    buffer_load_dwordx4 v46, s[20:23], s40 offen offset:2048 lds
    buffer_load_dwordx4 v47, s[20:23], s40 offen offset:3072 lds
    s_add_u32 s40, s40, 131072
    s_add_u32 s44, s42, 49152
    s_mov_b32 m0, s44
    s_nop 0
    buffer_load_dwordx4 v44, s[20:23], s40 offen offset:0 lds
    buffer_load_dwordx4 v45, s[20:23], s40 offen offset:1024 lds
    buffer_load_dwordx4 v46, s[20:23], s40 offen offset:2048 lds
    buffer_load_dwordx4 v47, s[20:23], s40 offen offset:3072 lds
    s_add_u32 s40, s40, 131072
    s_add_u32 s44, s42, 53248
    s_mov_b32 m0, s44
    s_nop 0
    buffer_load_dwordx4 v44, s[20:23], s40 offen offset:0 lds
    buffer_load_dwordx4 v45, s[20:23], s40 offen offset:1024 lds
    buffer_load_dwordx4 v46, s[20:23], s40 offen offset:2048 lds
    buffer_load_dwordx4 v47, s[20:23], s40 offen offset:3072 lds
    s_add_u32 s40, s40, 131072
    s_waitcnt vmcnt(32)
    s_barrier
    s_add_u32 s44, s42, 57344
    s_mov_b32 m0, s44
    s_nop 0
    buffer_load_dwordx4 v44, s[20:23], s40 offen offset:0 lds
    buffer_load_dwordx4 v45, s[20:23], s40 offen offset:1024 lds
    buffer_load_dwordx4 v46, s[20:23], s40 offen offset:2048 lds
    buffer_load_dwordx4 v47, s[20:23], s40 offen offset:3072 lds
    s_add_u32 s40, s40, 131072
    s_add_u32 s44, s42, 61440
    s_mov_b32 m0, s44
    s_nop 0
    buffer_load_dwordx4 v44, s[20:23], s40 offen offset:0 lds
    buffer_load_dwordx4 v45, s[20:23], s40 offen offset:1024 lds
    buffer_load_dwordx4 v46, s[20:23], s40 offen offset:2048 lds
    buffer_load_dwordx4 v47, s[20:23], s40 offen offset:3072 lds
    s_add_u32 s40, s40, 131072
    s_add_u32 s44, s42, 0
    s_mov_b32 m0, s44
    s_nop 0
    buffer_load_dwordx4 v44, s[20:23], s40 offen offset:0 lds
    buffer_load_dwordx4 v45, s[20:23], s40 offen offset:1024 lds
    buffer_load_dwordx4 v46, s[20:23], s40 offen offset:2048 lds
    buffer_load_dwordx4 v47, s[20:23], s40 offen offset:3072 lds
    s_add_u32 s40, s40, 131072
    s_add_u32 s44, s42, 4096
    s_mov_b32 m0, s44
    s_nop 0
    buffer_load_dwordx4 v44, s[20:23], s40 offen offset:0 lds
    buffer_load_dwordx4 v45, s[20:23], s40 offen offset:1024 lds
    buffer_load_dwordx4 v46, s[20:23], s40 offen offset:2048 lds
    buffer_load_dwordx4 v47, s[20:23], s40 offen offset:3072 lds
    s_add_u32 s40, s40, 131072
    s_waitcnt vmcnt(40)
    s_barrier
    s_add_u32 s44, s42, 8192
    s_mov_b32 m0, s44
    s_nop 0
    buffer_load_dwordx4 v44, s[20:23], s40 offen offset:0 lds
    buffer_load_dwordx4 v45, s[20:23], s40 offen offset:1024 lds
    buffer_load_dwordx4 v46, s[20:23], s40 offen offset:2048 lds
    buffer_load_dwordx4 v47, s[20:23], s40 offen offset:3072 lds
    s_add_u32 s40, s40, 131072
    s_add_u32 s44, s42, 12288
    s_mov_b32 m0, s44
    s_nop 0
    buffer_load_dwordx4 v44, s[20:23], s40 offen offset:0 lds
    buffer_load_dwordx4 v45, s[20:23], s40 offen offset:1024 lds
    buffer_load_dwordx4 v46, s[20:23], s40 offen offset:2048 lds
    buffer_load_dwordx4 v47, s[20:23], s40 offen offset:3072 lds
    s_add_u32 s40, s40, 131072
    s_add_u32 s44, s42, 16384
    s_mov_b32 m0, s44
    s_nop 0
    buffer_load_dwordx4 v44, s[20:23], s40 offen offset:0 lds
    buffer_load_dwordx4 v45, s[20:23], s40 offen offset:1024 lds
    buffer_load_dwordx4 v46, s[20:23], s40 offen offset:2048 lds
    buffer_load_dwordx4 v47, s[20:23], s40 offen offset:3072 lds
    s_add_u32 s40, s40, 131072
    s_add_u32 s44, s42, 20480
    s_mov_b32 m0, s44
    s_nop 0
    buffer_load_dwordx4 v44, s[20:23], s40 offen offset:0 lds
    buffer_load_dwordx4 v45, s[20:23], s40 offen offset:1024 lds
    buffer_load_dwordx4 v46, s[20:23], s40 offen offset:2048 lds
    buffer_load_dwordx4 v47, s[20:23], s40 offen offset:3072 lds
    s_add_u32 s40, s40, 131072
    s_waitcnt vmcnt(48)
    s_barrier
    s_add_u32 s44, s42, 24576
    s_mov_b32 m0, s44
    s_nop 0
    buffer_load_dwordx4 v44, s[20:23], s40 offen offset:0 lds
    buffer_load_dwordx4 v45, s[20:23], s40 offen offset:1024 lds
    buffer_load_dwordx4 v46, s[20:23], s40 offen offset:2048 lds
    buffer_load_dwordx4 v47, s[20:23], s40 offen offset:3072 lds
    s_add_u32 s40, s40, 131072
    s_add_u32 s44, s42, 28672
    s_mov_b32 m0, s44
    s_nop 0
    buffer_load_dwordx4 v44, s[20:23], s40 offen offset:0 lds
    buffer_load_dwordx4 v45, s[20:23], s40 offen offset:1024 lds
    buffer_load_dwordx4 v46, s[20:23], s40 offen offset:2048 lds
    buffer_load_dwordx4 v47, s[20:23], s40 offen offset:3072 lds
    s_add_u32 s40, s40, 131072
    s_waitcnt vmcnt(48)
    s_barrier
    s_add_u32 s44, s42, 32768
    s_mov_b32 m0, s44
    s_nop 0
    buffer_load_dwordx4 v44, s[20:23], s40 offen offset:0 lds
    buffer_load_dwordx4 v45, s[20:23], s40 offen offset:1024 lds
    buffer_load_dwordx4 v46, s[20:23], s40 offen offset:2048 lds
    buffer_load_dwordx4 v47, s[20:23], s40 offen offset:3072 lds
    s_add_u32 s40, s40, 131072
    s_add_u32 s44, s42, 36864
    s_mov_b32 m0, s44
    s_nop 0
    buffer_load_dwordx4 v44, s[20:23], s40 offen offset:0 lds
    buffer_load_dwordx4 v45, s[20:23], s40 offen offset:1024 lds
    buffer_load_dwordx4 v46, s[20:23], s40 offen offset:2048 lds
    buffer_load_dwordx4 v47, s[20:23], s40 offen offset:3072 lds
    s_add_u32 s40, s40, 131072
    s_waitcnt vmcnt(48)
    s_barrier
    s_add_u32 s44, s42, 40960
    s_mov_b32 m0, s44
    s_nop 0
    buffer_load_dwordx4 v44, s[20:23], s40 offen offset:0 lds
    buffer_load_dwordx4 v45, s[20:23], s40 offen offset:1024 lds
    buffer_load_dwordx4 v46, s[20:23], s40 offen offset:2048 lds
    buffer_load_dwordx4 v47, s[20:23], s40 offen offset:3072 lds
    s_add_u32 s40, s40, 131072
    s_add_u32 s44, s42, 45056
    s_mov_b32 m0, s44
    s_nop 0
    buffer_load_dwordx4 v44, s[20:23], s40 offen offset:0 lds
    buffer_load_dwordx4 v45, s[20:23], s40 offen offset:1024 lds
    buffer_load_dwordx4 v46, s[20:23], s40 offen offset:2048 lds
    buffer_load_dwordx4 v47, s[20:23], s40 offen offset:3072 lds
    s_add_u32 s40, s40, 131072
    s_waitcnt vmcnt(48)
    s_barrier
    s_waitcnt vmcnt(40)
    s_barrier
    s_waitcnt vmcnt(32)
    s_barrier
    s_waitcnt vmcnt(24)
    s_barrier
    s_waitcnt vmcnt(16)
    s_barrier
    s_waitcnt vmcnt(8)
    s_barrier
    s_waitcnt vmcnt(0)
    s_barrier
    s_lshr_b32 s43, s2, 3
    s_lshl_b32 s43, s43, 1
    s_add_u32 s43, s43, s53
    s_cmp_lg_u32 s99, 0
    s_cbranch_scc1 L_mlp2_0_kernel_nopf
    s_mov_b32 s56, s10
    s_and_b32 s57, s11, 0xffff
    s_mov_b32 s58, 0xc8000
    s_mov_b32 s59, 0x00020000
    s_mul_i32 s43, s43, 12800
    buffer_load_dwordx4 v[20:23], v3, s[56:59], s43 offen
    s_add_u32 s43, s43, 1024
    buffer_load_dwordx4 v[20:23], v3, s[56:59], s43 offen
    s_add_u32 s43, s43, 1024
    buffer_load_dwordx4 v[20:23], v3, s[56:59], s43 offen
    s_add_u32 s43, s43, 1024
    buffer_load_dwordx4 v[20:23], v3, s[56:59], s43 offen
    s_add_u32 s43, s43, 1024
    buffer_load_dwordx4 v[20:23], v3, s[56:59], s43 offen
    s_add_u32 s43, s43, 1024
    buffer_load_dwordx4 v[20:23], v3, s[56:59], s43 offen
    s_add_u32 s43, s43, 1024
    buffer_load_dwordx4 v[20:23], v3, s[56:59], s43 offen
    s_add_u32 s43, s43, 1024
    buffer_load_dwordx4 v[20:23], v3, s[56:59], s43 offen
    s_add_u32 s43, s43, 1024
    buffer_load_dwordx4 v[20:23], v3, s[56:59], s43 offen
    s_add_u32 s43, s43, 1024
    buffer_load_dwordx4 v[20:23], v3, s[56:59], s43 offen
    s_add_u32 s43, s43, 1024
    buffer_load_dwordx4 v[20:23], v3, s[56:59], s43 offen
    s_add_u32 s43, s43, 1024
    buffer_load_dwordx4 v[20:23], v3, s[56:59], s43 offen
    s_add_u32 s43, s43, 1024
    buffer_load_dwordx4 v[20:23], v3, s[56:59], s43 offen
    s_add_u32 s43, s43, 1024
L_mlp2_0_kernel_nopf:
    s_mov_b32 s32, s53
    s_getpc_b64 s[90:91]
L_pc_ref4:
    s_sub_u32 s90, s90, L_pc_ref4 - L_text_start
    s_subb_u32 s91, s91, 0
    s_lshr_b32 s92, s2, 3
    s_mul_i32 s92, s92, 4
    s_add_u32 s92, s92, s32
    s_lshl_b32 s92, s92, 9
    s_min_u32 s92, s92, L_text_end - L_text_start - 512
    s_add_u32 s90, s90, s92
    s_addc_u32 s91, s91, 0
    v_lshlrev_b32 v12, 3, v0
    global_load_dwordx2 v[20:21], v12, s[90:91]
    s_add_u32 s32, s32, 2
    s_getpc_b64 s[90:91]
L_pc_ref5:
    s_sub_u32 s90, s90, L_pc_ref5 - L_text_start
    s_subb_u32 s91, s91, 0
    s_lshr_b32 s92, s2, 3
    s_mul_i32 s92, s92, 4
    s_add_u32 s92, s92, s32
    s_lshl_b32 s92, s92, 9
    s_min_u32 s92, s92, L_text_end - L_text_start - 512
    s_add_u32 s90, s90, s92
    s_addc_u32 s91, s91, 0
    v_lshlrev_b32 v12, 3, v0
    global_load_dwordx2 v[20:21], v12, s[90:91]
    s_add_u32 s32, s32, 2
    s_barrier
    s_barrier
    s_barrier
    s_branch L_mlp2_0_kernel_end
L_mlp2_0_kernel_fin:
L_mlp2_0_kernel_end:
    s_endpgm
L_text_end:
.section .rodata,"a"
.p2align 6
.amdhsa_kernel qkv0_kernel
  .amdhsa_next_free_vgpr 160
  .amdhsa_next_free_sgpr 102
  .amdhsa_accum_offset 160
  .amdhsa_group_segment_fixed_size 0
  .amdhsa_kernarg_size 104
  .amdhsa_user_sgpr_count 2
  .amdhsa_user_sgpr_kernarg_segment_ptr 1
  .amdhsa_system_sgpr_workgroup_id_x 1
.end_amdhsa_kernel
.p2align 6
.amdhsa_kernel qkv1_kernel
  .amdhsa_next_free_vgpr 160
  .amdhsa_next_free_sgpr 102
  .amdhsa_accum_offset 160
  .amdhsa_group_segment_fixed_size 0
  .amdhsa_kernarg_size 104
  .amdhsa_user_sgpr_count 2
  .amdhsa_user_sgpr_kernarg_segment_ptr 1
  .amdhsa_system_sgpr_workgroup_id_x 1
.end_amdhsa_kernel
.p2align 6
.amdhsa_kernel attn0_kernel
  .amdhsa_next_free_vgpr 216
  .amdhsa_next_free_sgpr 102
  .amdhsa_accum_offset 216
  .amdhsa_group_segment_fixed_size 0
  .amdhsa_kernarg_size 104
  .amdhsa_user_sgpr_count 2
  .amdhsa_user_sgpr_kernarg_segment_ptr 1
  .amdhsa_system_sgpr_workgroup_id_x 1
.end_amdhsa_kernel
.p2align 6
.amdhsa_kernel attn1_kernel
  .amdhsa_next_free_vgpr 216
  .amdhsa_next_free_sgpr 102
  .amdhsa_accum_offset 216
  .amdhsa_group_segment_fixed_size 0
  .amdhsa_kernarg_size 104
  .amdhsa_user_sgpr_count 2
  .amdhsa_user_sgpr_kernarg_segment_ptr 1
  .amdhsa_system_sgpr_workgroup_id_x 1
.end_amdhsa_kernel
.p2align 6
.amdhsa_kernel mlp1_0_kernel
  .amdhsa_next_free_vgpr 256
  .amdhsa_next_free_sgpr 102
  .amdhsa_accum_offset 176
  .amdhsa_group_segment_fixed_size 0
  .amdhsa_kernarg_size 104
  .amdhsa_user_sgpr_count 2
  .amdhsa_user_sgpr_kernarg_segment_ptr 1
  .amdhsa_system_sgpr_workgroup_id_x 1
.end_amdhsa_kernel
.p2align 6
.amdhsa_kernel mlp2_0_kernel
  .amdhsa_next_free_vgpr 168
  .amdhsa_next_free_sgpr 102
  .amdhsa_accum_offset 168
  .amdhsa_group_segment_fixed_size 0
  .amdhsa_kernarg_size 104
  .amdhsa_user_sgpr_count 2
  .amdhsa_user_sgpr_kernarg_segment_ptr 1
  .amdhsa_system_sgpr_workgroup_id_x 1
.end_amdhsa_kernel
.p2align 6
.amdhsa_kernel mlp2_1_kernel
  .amdhsa_next_free_vgpr 168
  .amdhsa_next_free_sgpr 102
  .amdhsa_accum_offset 168
  .amdhsa_group_segment_fixed_size 0
  .amdhsa_kernarg_size 104
  .amdhsa_user_sgpr_count 2
  .amdhsa_user_sgpr_kernarg_segment_ptr 1
  .amdhsa_system_sgpr_workgroup_id_x 1
.end_amdhsa_kernel
```
